```python
import torch

def _softmax(x, axis=-1):
    return torch.softmax(x, dim=axis)
def _gelu(x):
    return torch.nn.functional.gelu(x, approximate="tanh")
def _silu(x):
    return torch.nn.functional.silu(x)
def _sigmoid(x):
    return torch.sigmoid(x)
def _layernorm(x, axis=-1, eps=1e-5):
    m = x.mean(dim=axis, keepdim=True)
    v = x.var(dim=axis, keepdim=True, unbiased=False)
    return (x - m) / torch.sqrt(v + eps)
def _scatter_add(tgt, idx, src, axis=0):
    return tgt.clone().index_add_(axis, idx, src)
def _segment_sum(src, seg, n):
    out = torch.zeros((n,) + src.shape[1:], dtype=src.dtype)
    return out.index_add_(0, seg, src)
def _pad(x, pw):
    flat = tuple(v for pair in reversed(pw) for v in pair)
    return torch.nn.functional.pad(x, flat)

kernel_name = 'interleave_layers__sliding_block_cached__sliding_block_cached__decode'

def setup_inputs():

    _w = (lambda a: (lambda t: t.to(torch.bfloat16) if t.is_floating_point() else t)(torch.as_tensor(a)))
    def _A_setup():
        B, Sq, D = 8, 1, 448
        Hq, Hkv, Sk, Dh = 16, 8, 4096, 256
        assert Hq % Hkv == 0, (Hq, Hkv)
        return {
            "x": _w((lambda *s: torch.randn(*s, dtype=torch.bfloat16) * 0.1)(B, Sq, D)),
            "k_cache": _w((lambda *s: torch.randn(*s, dtype=torch.bfloat16) * 0.8)(B, Hkv, Sk, Dh)),
            "v_cache": _w((lambda *s: torch.randn(*s, dtype=torch.bfloat16) * 3.2)(B, Hkv, Sk, Dh)),
            "wq": _w((lambda *s: torch.randn(*s, dtype=torch.bfloat16) * 0.8)(D, Hq * Dh) * (D ** -0.5)),
            "wo": _w((lambda *s: torch.randn(*s, dtype=torch.bfloat16) * 3.2)(Hq * Dh, D) * ((Hq * Dh) ** -0.5)),
        }
    _A_in = _A_setup()

    def _B_setup():
        B, Sq, D = 8, 1, 448
        Hq, Hkv, Sk, Dh = 16, 8, 4096, 256
        assert Hq % Hkv == 0, (Hq, Hkv)
        return {
            "x": _w((lambda *s: torch.randn(*s, dtype=torch.bfloat16) * 0.1)(B, Sq, D)),
            "k_cache": _w((lambda *s: torch.randn(*s, dtype=torch.bfloat16) * 0.8)(B, Hkv, Sk, Dh)),
            "v_cache": _w((lambda *s: torch.randn(*s, dtype=torch.bfloat16) * 1.6)(B, Hkv, Sk, Dh)),
            "wq": _w((lambda *s: torch.randn(*s, dtype=torch.bfloat16) * 0.8)(D, Hq * Dh) * (D ** -0.5)),
            "wo": _w((lambda *s: torch.randn(*s, dtype=torch.bfloat16) * 1.6)(Hq * Dh, D) * ((Hq * Dh) ** -0.5)),
        }
    _B_in = _B_setup()

    return {
        "A_x": _A_in["x"],
        "A_k_cache": _A_in["k_cache"],
        "A_v_cache": _A_in["v_cache"],
        "A_wq": _A_in["wq"],
        "A_wo": _A_in["wo"],
        "B_x": _B_in["x"],
        "B_k_cache": _B_in["k_cache"],
        "B_v_cache": _B_in["v_cache"],
        "B_wq": _B_in["wq"],
        "B_wo": _B_in["wo"],
    }

def reference(A_x, A_k_cache, A_v_cache, A_wq, A_wo, B_x, B_k_cache, B_v_cache, B_wq, B_wo):
    def _A_ref(x, k_cache, v_cache, wq, wo):
        B, Sq, D = x.shape
        Hq, Dh = 16, 256
        Hkv, Sk = k_cache.shape[1], k_cache.shape[2]
        W = min(4096, max(256, Sk // 4))
        rep = Hq // Hkv
        q = (lambda x, *d: x.permute(*d))((x @ wq).reshape(B, Sq, Hq, Dh), 0, 2, 1, 3)
        k = (lambda x, n, axis: torch.repeat_interleave(x, n, dim=axis))(k_cache[:, :, Sk - W:, :], rep, axis=1)
        v = (lambda x, n, axis: torch.repeat_interleave(x, n, dim=axis))(v_cache[:, :, Sk - W:, :], rep, axis=1)
        scores = torch.einsum("bhqd,bhkd->bhqk", q, k) * (Dh ** -0.5)
        p = _softmax(scores, axis=-1)
        o = torch.einsum("bhqk,bhkd->bhqd", p, v)
        return (lambda x, *d: x.permute(*d))(o, 0, 2, 1, 3).reshape(B, Sq, Hq * Dh) @ wo

    def _B_ref(x, k_cache, v_cache, wq, wo):
        B, Sq, D = x.shape
        Hq, Dh = 16, 256
        Hkv, Sk = k_cache.shape[1], k_cache.shape[2]
        W = min(4096, max(256, Sk // 4))
        rep = Hq // Hkv
        q = (lambda x, *d: x.permute(*d))((x @ wq).reshape(B, Sq, Hq, Dh), 0, 2, 1, 3)
        k = (lambda x, n, axis: torch.repeat_interleave(x, n, dim=axis))(k_cache[:, :, Sk - W:, :], rep, axis=1)
        v = (lambda x, n, axis: torch.repeat_interleave(x, n, dim=axis))(v_cache[:, :, Sk - W:, :], rep, axis=1)
        scores = torch.einsum("bhqd,bhkd->bhqk", q, k) * (Dh ** -0.5)
        p = _softmax(scores, axis=-1)
        o = torch.einsum("bhqk,bhkd->bhqd", p, v)
        return (lambda x, *d: x.permute(*d))(o, 0, 2, 1, 3).reshape(B, Sq, Hq * Dh) @ wo

    x = A_x
    x = x + _A_ref(_layernorm(x, axis=-1), A_k_cache, A_v_cache, A_wq, A_wo)
    x = x + _B_ref(_layernorm(x, axis=-1), B_k_cache, B_v_cache, B_wq, B_wo)
    x = x + _A_ref(_layernorm(x, axis=-1), A_k_cache, A_v_cache, A_wq, A_wo)
    x = x + _B_ref(_layernorm(x, axis=-1), B_k_cache, B_v_cache, B_wq, B_wo)
    return x
```

```asm
; @launch grid=(256,1,1) block=(256,1,1) lds=163840
.amdgcn_target "amdgcn-amd-amdhsa--gfx950"
.text
.globl interleave_layers__sliding_block_cached__sliding_block_cached__decode_kernel
.p2align 8
.type interleave_layers__sliding_block_cached__sliding_block_cached__decode_kernel,@function
interleave_layers__sliding_block_cached__sliding_block_cached__decode_kernel:
s_cmp_ge_u32 s2, 256
s_cbranch_scc1 L_EXIT
s_load_dwordx16 s[8:23], s[0:1], 0
s_load_dwordx8 s[24:31], s[0:1], 64
s_load_dwordx2 s[32:33], s[0:1], 96
s_getpc_b64 s[80:81]
L_PC:
v_lshrrev_b32 v8, 6, v0
v_and_b32 v9, 63, v0
v_lshlrev_b32 v30, 4, v0
s_and_b32 s34, s2, 7
s_lshr_b32 s35, s2, 3
v_readfirstlane_b32 s52, v8
v_lshlrev_b32 v0, 4, v9
s_and_b32 s90, s35, 7
s_lshr_b32 s91, s35, 3
s_lshl_b32 s53, s90, 3
s_add_u32 s53, s53, s34
s_lshl_b32 s53, s53, 21
s_lshl_b32 s77, s91, 17
s_add_u32 s53, s53, s77
s_add_u32 s53, s53, 0x180000
s_mov_b32 s39, 0x20000
v_lshrrev_b32 v12, 5, v0
v_lshlrev_b32 v12, 13, v12
v_and_or_b32 v12, v0, 16, v12
s_lshl_b32 s77, s52, 20
s_lshl_b32 s78, s34, 10
s_add_u32 s77, s77, s78
s_lshl_b32 s78, s35, 5
s_add_u32 s77, s77, s78
s_lshl_b32 s78, s52, 12
s_add_u32 s78, s78, 131072
v_lshrrev_b32 v5, 5, v0
v_and_b32 v5, 16, v5
v_xor_b32 v3, v5, v0
s_lshl_b32 s54, s52, 10
v_mov_b32 v24, -1
v_mov_b32 v25, -1
v_mov_b32 v26, -1
v_mov_b32 v27, -1
s_lshl_b32 s75, s2, 12
s_add_u32 s75, s75, 65536
s_add_u32 s76, s75, 0x100000
s_add_u32 s65, s75, 0x200000
s_mov_b32 s46, 2686976
s_mov_b32 s47, 0x20000
v_bfe_u32 v13, v9, 2, 3
v_lshrrev_b32 v14, 5, v9
v_lshl_add_u32 v14, v8, 1, v14
s_and_b32 s64, s35, 16
s_and_b32 s55, s35, 15
s_lshl_b32 s55, s55, 6
s_add_u32 s64, s64, s55
v_lshlrev_b32 v15, 10, v14
v_and_b32 v16, 1, v13
v_lshl_add_u32 v15, v16, 5, v15
v_lshrrev_b32 v16, 1, v13
v_lshl_add_u32 v15, v16, 2, v15
v_add_u32 v119, s64, v15
s_lshl_b32 s69, s34, 13
s_waitcnt lgkmcnt(0)
s_mov_b32 s44, s32
s_mov_b32 s45, s33
buffer_store_dwordx4 v[24:27], v30, s[44:47], s75 offen sc1
buffer_store_dwordx4 v[24:27], v30, s[44:47], s76 offen sc1
buffer_store_dwordx4 v[24:27], v30, s[44:47], s65 offen sc1
buffer_store_dword v24, v119, s[44:47], s69 offen sc1
s_mov_b32 s36, s14
s_mov_b32 s37, s15
s_mov_b32 s38, 3670016
s_add_u32 m0, s78, 0
s_add_u32 s79, s77, 0
buffer_load_dwordx4 v12, s[36:39], s79 offen nt lds
s_add_u32 m0, s78, 1024
s_add_u32 s79, s77, 262144
buffer_load_dwordx4 v12, s[36:39], s79 offen nt lds
s_add_u32 m0, s78, 2048
s_add_u32 s79, s77, 524288
buffer_load_dwordx4 v12, s[36:39], s79 offen nt lds
s_add_u32 m0, s78, 3072
s_add_u32 s79, s77, 786432
buffer_load_dwordx4 v12, s[36:39], s79 offen nt lds
s_add_u32 s36, s10, s53
s_addc_u32 s37, s11, 0
s_mov_b32 s38, 0x20000
s_mov_b32 m0, s54
s_add_u32 s54, s54, 4096
buffer_load_dwordx4 v3, s[36:39], m0 offen nt lds
s_mov_b32 m0, s54
s_add_u32 s54, s54, 4096
v_xor_b32 v5, 32, v3
buffer_load_dwordx4 v5, s[36:39], m0 offen nt lds
s_and_b32 s82, s35, 7
s_lshl_b32 s82, s82, 12
v_add_u32 v11, s82, v30
v_min_u32 v11, L_CODE_END-L_PC-16, v11
global_load_dwordx4 a[200:203], v11, s[80:81]
s_mov_b32 s55, 8
s_mov_b32 s56, 64
s_mov_b32 s59, 14
s_mov_b32 s57, 14
s_mov_b32 s40, s32
s_mov_b32 s41, s33
s_mov_b32 s42, 0
s_mov_b32 s43, 0x20000
s_mov_b32 s4, s32
s_mov_b32 s5, s33
s_mov_b32 s6, 2686976
s_mov_b32 s7, 0x20000
s_mov_b32 s48, s8
s_mov_b32 s49, s9
s_mov_b32 s50, 7168
s_mov_b32 s51, 0x20000
s_cmp_ge_u32 s35, 14
s_cselect_b32 s92, 1, 0
s_mul_i32 s77, s92, 14
s_sub_u32 s93, s35, s77
v_and_b32 v10, 15, v9
v_lshrrev_b32 v11, 4, v9
s_lshl_b32 s77, s52, 10
v_mul_u32_u24 v12, 896, v10
v_lshl_add_u32 v12, v11, 4, v12
s_lshl_b32 s78, s52, 8
v_add_u32 v12, s78, v12
s_cmp_eq_u32 s52, 3
s_cselect_b32 s78, 0x40000000, 0
v_add_u32 v13, s78, v12
s_mov_b32 exec_lo, 0x00ff00ff
s_mov_b32 exec_hi, 0x00ff00ff
buffer_load_dwordx4 v[40:43], v12, s[48:51], 0 offen offset:0
buffer_load_dwordx4 v[44:47], v12, s[48:51], 0 offen offset:64
buffer_load_dwordx4 v[48:51], v13, s[48:51], 0 offen offset:128
buffer_load_dwordx4 v[52:55], v13, s[48:51], 0 offen offset:192
s_mov_b64 exec, -1
v_lshlrev_b32 v12, 4, v10
v_lshl_add_u32 v12, v11, 7, v12
s_lshl_b32 s78, s52, 11
v_add_u32 v112, s78, v12
v_lshrrev_b32 v12, 1, v10
v_lshlrev_b32 v12, 12, v12
v_and_b32 v13, 1, v10
v_lshl_add_u32 v12, v13, 9, v12
v_xor_b32 v14, v11, v10
v_lshl_add_u32 v12, v14, 4, v12
v_add_u32 v4, s77, v12
s_mul_i32 s78, s52, 2112
s_add_u32 s78, s78, 152064
v_lshlrev_b32 v12, 2, v9
v_add_u32 v114, s78, v12
v_and_b32 v12, 3, v9
v_mul_u32_u24 v12, 2112, v12
v_add_u32 v12, 152064, v12
v_bfe_u32 v13, v9, 2, 3
v_lshrrev_b32 v14, 5, v9
s_lshl_b32 s78, s52, 1
v_add_u32 v14, s78, v14
v_lshrrev_b32 v15, 2, v14
v_lshlrev_b32 v15, 6, v15
v_and_b32 v16, 3, v14
v_lshl_add_u32 v15, v16, 8, v15
v_add_u32 v15, v15, v12
v_lshl_add_u32 v115, v13, 3, v15
v_lshl_add_u32 v116, v13, 3, v12
v_lshl_add_u32 v117, v14, 2, v15
v_lshl_add_u32 v118, v14, 2, v12
s_mov_b32 s86, 0x00ff00ff
s_mov_b32 s87, 0x00ff00ff
s_mov_b32 s88, 0x11111111
s_mov_b32 s89, 0x11111111
s_mov_b32 s66, 0
s_mov_b32 s68, 2000000
s_mul_i32 s74, s34, 53248
s_add_u32 s74, s74, 65536
s_add_u32 s70, s74, 0x4000
s_add_u32 s72, s74, 0xC000
s_mov_b32 s73, 1769472
s_lshl_b32 s95, s35, 13
s_add_u32 s95, s95, 1769472
v_lshrrev_b32 v12, 2, v10
v_and_b32 v13, 3, v9
v_and_b32 v14, 1, v11
v_lshrrev_b32 v17, 1, v11
v_lshlrev_b32 v18, 5, v14
v_lshl_add_u32 v18, v12, 3, v18
v_lshl_add_u32 v18, v17, 1, v18
v_lshlrev_b32 v19, 3, v14
v_lshl_add_u32 v19, v12, 1, v19
s_lshl_b32 s77, s52, 3
v_lshrrev_b32 v20, 1, v13
v_add_u32 v20, s77, v20
v_xor_b32 v20, v20, v19
v_lshlrev_b32 v18, 9, v18
v_lshl_add_u32 v18, v20, 4, v18
v_and_b32 v20, 1, v13
v_lshl_add_u32 v6, v20, 3, v18
v_and_b32 v14, 1, v9
v_bfe_u32 v15, v10, 1, 1
v_cmp_eq_u32 vcc, 1, v15
v_mov_b32 v16, 0x4444
v_mov_b32 v17, 0xeeee
v_cndmask_b32 v7, v16, v17, vcc
v_cmp_eq_u32 vcc, 1, v14
v_mov_b32 v16, 0x01000504
v_mov_b32 v17, 0x07060302
v_cndmask_b32 v127, v16, v17, vcc
v_lshlrev_b32 v16, 4, v13
v_lshl_add_u32 v16, v11, 6, v16
s_lshl_b32 s77, s90, 10
v_add_u32 v120, s77, v16
s_mul_i32 s77, s52, 320
s_add_u32 s77, s77, 147456
v_lshlrev_b32 v16, 10, v11
v_bfe_u32 v17, v10, 2, 1
v_lshl_add_u32 v16, v17, 5, v16
v_and_b32 v17, 8, v10
v_add_u32 v16, v16, v17
v_lshl_add_u32 v16, v14, 2, v16
v_lshl_add_u32 v16, v15, 1, v16
v_add_u32 v121, s77, v16
s_and_b32 s77, s90, 3
s_lshl_b32 s77, s77, 2
s_add_u32 s77, s77, s91
s_lshl_b32 s77, s77, 4
s_lshr_b32 s78, s90, 2
s_lshl_b32 s78, s78, 10
s_add_u32 s77, s77, s78
s_lshl_b32 s78, s52, 12
s_add_u32 s77, s77, s78
v_and_b32 v16, 6, v9
v_lshlrev_b32 v16, 1, v16
v_lshl_add_u32 v16, v14, 14, v16
v_lshrrev_b32 v17, 5, v9
v_lshl_add_u32 v16, v17, 11, v16
v_bfe_u32 v17, v9, 3, 2
v_lshl_add_u32 v16, v17, 8, v16
v_add_u32 v122, s77, v16
s_lshl_b32 s77, s92, 14
s_add_u32 s77, s77, s78
v_add_u32 v123, s77, v0
v_and_b32 v16, 7, v9
v_lshlrev_b32 v16, 4, v16
v_lshl_add_u32 v16, v11, 7, v16
s_lshl_b32 s77, s92, 10
v_add_u32 v124, s77, v16
s_and_b32 s77, s52, 1
s_lshr_b32 s78, s52, 1
s_lshl_b32 s79, s77, 1
s_add_u32 s79, s79, s78
s_lshl_b32 s79, s79, 8
s_add_u32 s79, s79, 152064
v_lshlrev_b32 v16, 2, v9
v_add_u32 v125, s79, v16
s_lshl_b32 s79, s93, 1
s_add_u32 s79, s79, s78
s_lshl_b32 s79, s79, 13
s_lshl_b32 s80, s34, 1
s_add_u32 s80, s80, s92
s_lshl_b32 s80, s80, 9
s_add_u32 s79, s79, s80
s_lshl_b32 s77, s77, 8
s_add_u32 s79, s79, s77
v_lshlrev_b32 v16, 2, v9
v_add_u32 v126, s79, v16
s_and_b32 s77, s90, 3
s_lshl_b32 s77, s77, 7
s_lshr_b32 s90, s90, 2
s_lshl_b32 s90, s90, 6
s_add_u32 s90, s90, s77
s_lshl_b32 s91, s91, 4
s_add_u32 s90, s90, s91
s_lshr_b32 s77, s52, 1
s_lshl_b32 s77, s77, 9
s_add_u32 s90, s90, s77
s_and_b32 s77, s52, 1
s_lshl_b32 s77, s77, 3
s_add_u32 s90, s90, s77
s_mov_b32 s91, 4294903808
s_mov_b32 s8, 0xaaaaaaaa
s_mov_b32 s9, 0xaaaaaaaa
v_bfe_u32 v16, v9, 1, 1
v_lshlrev_b32 v16, 7, v16
v_bfe_u32 v17, v9, 2, 3
v_lshl_add_u32 v16, v17, 4, v16
v_lshl_add_u32 v16, v14, 3, v16
v_lshrrev_b32 v17, 5, v9
v_lshl_add_u32 v16, v17, 2, v16
s_lshl_b32 s77, s35, 8
s_cmp_eq_u32 s52, 0
s_cselect_b32 s77, s77, 0x40000000
v_add_u32 v113, s77, v16
v_mov_b32 v24, 0
v_mov_b32 v25, 0
v_mov_b32 v26, 0
v_mov_b32 v27, 0
v_add_u32 v12, 147456, v30
ds_write_b128 v12, v[24:27]
v_mov_b32 v12, 151616
ds_write_b64 v12, v[24:25]
s_getreg_b32 s77, hwreg(HW_REG_XCC_ID)
s_and_b32 s77, s77, 15
s_mul_i32 s78, s77, s77
s_lshl_b32 s77, s77, 6
s_lshl_b32 s78, s78, 15
s_add_u32 s77, s77, s78
s_add_u32 s77, s77, 1
s_lshl_b32 s94, s77, 5
v_mov_b32 v28, s77
s_lshl_b32 s78, s34, 5
v_mov_b32 v29, s78
s_mov_b32 m0, s54
s_add_u32 s54, s54, 4096
v_xor_b32 v5, 64, v3
buffer_load_dwordx4 v5, s[36:39], m0 offen nt lds
s_mov_b32 m0, s54
s_add_u32 s54, s54, 4096
v_xor_b32 v5, 96, v3
buffer_load_dwordx4 v5, s[36:39], m0 offen nt lds
s_mov_b32 m0, s54
s_add_u32 s54, s54, 4096
v_xor_b32 v5, 128, v3
buffer_load_dwordx4 v5, s[36:39], m0 offen nt lds
s_mov_b32 m0, s54
s_add_u32 s54, s54, 4096
v_xor_b32 v5, 160, v3
buffer_load_dwordx4 v5, s[36:39], m0 offen nt lds
s_mov_b32 m0, s54
s_add_u32 s54, s54, 4096
v_xor_b32 v5, 192, v3
buffer_load_dwordx4 v5, s[36:39], m0 offen nt lds
s_mov_b32 m0, s54
s_add_u32 s54, s54, 4096
v_xor_b32 v5, 224, v3
buffer_load_dwordx4 v5, s[36:39], m0 offen nt lds
s_branch L_Q0
L_QAP:
s_waitcnt vmcnt(0) lgkmcnt(0)
s_barrier
s_mov_b64 exec, s[86:87]
buffer_load_dwordx4 v[8:11], v112, s[48:51], 0 offen offset:0 sc1
buffer_load_dwordx4 v[12:15], v112, s[48:51], 0 offen offset:512 sc1
buffer_load_dwordx4 v[16:19], v112, s[48:51], 0 offen offset:1024 sc1
buffer_load_dwordx4 v[20:23], v112, s[48:51], 0 offen offset:1536 sc1
s_mov_b64 exec, -1
s_not_b64 exec, s[86:87]
v_mov_b32 v8, 0x3f803f80
v_mov_b32 v9, 0x3f803f80
v_mov_b32 v10, 0x3f803f80
v_mov_b32 v11, 0x3f803f80
v_mov_b32 v12, 0x3f803f80
v_mov_b32 v13, 0x3f803f80
v_mov_b32 v14, 0x3f803f80
v_mov_b32 v15, 0x3f803f80
v_mov_b32 v16, 0x3f803f80
v_mov_b32 v17, 0x3f803f80
v_mov_b32 v18, 0x3f803f80
v_mov_b32 v19, 0x3f803f80
v_mov_b32 v20, 0x3f803f80
v_mov_b32 v21, 0x3f803f80
v_mov_b32 v22, 0x3f803f80
v_mov_b32 v23, 0x3f803f80
s_mov_b64 exec, -1
L_QAR:
s_mov_b64 exec, s[86:87]
buffer_load_dwordx4 v[8:11], v112, s[48:51], 0 offen offset:0 sc1
buffer_load_dwordx4 v[12:15], v112, s[48:51], 0 offen offset:512 sc1
buffer_load_dwordx4 v[16:19], v112, s[48:51], 0 offen offset:1024 sc1
buffer_load_dwordx4 v[20:23], v112, s[48:51], 0 offen offset:1536 sc1
s_mov_b64 exec, -1
s_waitcnt vmcnt(4)
L_QAC:
v_max3_u32 v32, v8, v9, v10
v_max3_u32 v32, v32, v11, v12
v_max3_u32 v32, v32, v13, v14
v_max3_u32 v32, v32, v15, v16
v_max3_u32 v32, v32, v17, v18
v_max3_u32 v32, v32, v19, v20
v_max3_u32 v32, v32, v21, v22
v_max_u32 v32, v32, v23
v_cmp_eq_u32 vcc, -1, v32
v_mfma_f32_16x16x32_bf16 v[28:31], v[8:11], v[8:11], 0
s_cbranch_vccnz L_QAF
L_QAOK:
v_mfma_f32_16x16x32_bf16 v[24:27], v[8:11], v[64:67], 0
v_mfma_f32_16x16x32_bf16 v[28:31], v[12:15], v[12:15], v[28:31]
v_mfma_f32_16x16x32_bf16 v[24:27], v[12:15], v[68:71], v[24:27]
v_mfma_f32_16x16x32_bf16 v[28:31], v[16:19], v[16:19], v[28:31]
v_mfma_f32_16x16x32_bf16 v[24:27], v[16:19], v[72:75], v[24:27]
v_mfma_f32_16x16x32_bf16 v[28:31], v[20:23], v[20:23], v[28:31]
v_mfma_f32_16x16x32_bf16 v[24:27], v[20:23], v[76:79], v[24:27]
L_QJ:
s_nop 3
ds_write2st64_b32 v114, v28, v29 offset0:4 offset1:5
ds_write2st64_b32 v114, v30, v31 offset0:6 offset1:7
s_nop 1
ds_write2st64_b32 v114, v24, v25 offset0:0 offset1:1
ds_write2st64_b32 v114, v26, v27 offset0:2 offset1:3
s_waitcnt lgkmcnt(0)
s_barrier
ds_read_b32 v37, v118 offset:1152
ds_read_b32 v36, v117 offset:1024
ds_read_b64 v[32:33], v115
ds_read_b64 v[34:35], v116 offset:128
s_waitcnt lgkmcnt(2)
v_add_f32_dpp v37, v37, v37 quad_perm:[1,0,3,2] row_mask:0xf bank_mask:0xf
v_add_f32_dpp v36, v36, v36 quad_perm:[1,0,3,2] row_mask:0xf bank_mask:0xf
s_waitcnt lgkmcnt(0)
v_add_f32_dpp v37, v37, v37 quad_perm:[2,3,0,1] row_mask:0xf bank_mask:0xf
v_add_f32_dpp v36, v36, v36 quad_perm:[2,3,0,1] row_mask:0xf bank_mask:0xf
v_mul_f32 v37, 991054117, v37
v_mul_f32 v36, 991054117, v36
v_pk_fma_f32 v[32:33], v[34:35], v[36:37], v[32:33] op_sel:[0,1,0] op_sel_hi:[1,1,1] neg_lo:[1,0,0] neg_hi:[1,0,0]
v_fma_f32 v36, -v37, v37, v36
v_max_f32 v36, 0, v36
v_add_f32_dpp v32, v32, v32 quad_perm:[1,0,3,2] row_mask:0xf bank_mask:0xf
v_add_f32_dpp v33, v33, v33 quad_perm:[1,0,3,2] row_mask:0xf bank_mask:0xf
v_add_f32 v36, 925353388, v36
v_rsq_f32 v36, v36
v_add_f32_dpp v32, v32, v32 quad_perm:[2,3,0,1] row_mask:0xf bank_mask:0xf
v_add_f32_dpp v33, v33, v33 quad_perm:[2,3,0,1] row_mask:0xf bank_mask:0xf
v_mul_f32 v36, 1035512379, v36
s_mov_b64 exec, s[88:89]
v_pk_mul_f32 v[32:33], v[32:33], v[36:37] op_sel:[0,0] op_sel_hi:[1,0]
v_cvt_pk_bf16_f32 v56, v32, v33
v_min_u32 v56, -2, v56
buffer_store_dword v56, v119, s[40:43], s69 offen
buffer_store_dword v56, v119, s[4:7], s69 offen sc1
s_mov_b64 exec, -1
s_cmp_lt_u32 s66, 2
s_cbranch_scc1 L_INIT
L_INITD:
s_lshl_b32 s77, s52, 3
s_add_u32 s77, s77, 151552
v_mov_b32 v61, s77
v_add_u32 v62, 147456, v0
v_lshrrev_b32 v63, 8, v0
v_lshlrev_b32 v63, 3, v63
v_add_u32 v63, 151552, v63
v_and_b32 v60, 0x1c00, v120
v_add_u32 v60, v60, v0
s_bitcmp1_b32 s66, 0
s_cbranch_scc1 L_ABP
L_AAP:
s_cmp_lt_u32 s66, 2
s_cbranch_scc1 L_AAS0
s_waitcnt vmcnt(0)
buffer_load_dwordx4 v[8:11], v120, s[44:47], s69 offen offset:0 sc1
buffer_load_dwordx4 v[12:15], v120, s[44:47], s69 offen offset:256 sc1
buffer_load_dwordx4 v[16:19], v120, s[44:47], s69 offen offset:512 sc1
buffer_load_dwordx4 v[20:23], v120, s[44:47], s69 offen offset:768 sc1
v_mov_b32 v24, 0
v_mov_b32 v25, 0
v_mov_b32 v26, 0
v_mov_b32 v27, 0
v_mov_b32 v28, 0
v_mov_b32 v29, 0
v_mov_b32 v30, 0
v_mov_b32 v31, 0
v_mov_b32 v32, 0
v_mov_b32 v33, 0
v_mov_b32 v34, 0
v_mov_b32 v35, 0
v_mov_b32 v36, 0
v_mov_b32 v37, 0
v_mov_b32 v38, 0
v_mov_b32 v39, 0
v_mov_b32 v40, 0
v_mov_b32 v41, 0
v_mov_b32 v42, 0
v_mov_b32 v43, 0
v_mov_b32 v44, 0
v_mov_b32 v45, 0
v_mov_b32 v46, 0
v_mov_b32 v47, 0
v_mov_b32 v48, 0
v_mov_b32 v49, 0
v_mov_b32 v50, 0
v_mov_b32 v51, 0
v_mov_b32 v52, 0
v_mov_b32 v53, 0
v_mov_b32 v54, 0
v_mov_b32 v55, 0
L_AAR:
buffer_load_dwordx4 v[8:11], v120, s[44:47], s69 offen offset:0 sc1
buffer_load_dwordx4 v[12:15], v120, s[44:47], s69 offen offset:256 sc1
buffer_load_dwordx4 v[16:19], v120, s[44:47], s69 offen offset:512 sc1
buffer_load_dwordx4 v[20:23], v120, s[44:47], s69 offen offset:768 sc1
s_waitcnt vmcnt(4)
L_AAC:
v_max3_u32 v58, v8, v9, v10
v_max3_u32 v58, v58, v11, v12
v_max3_u32 v58, v58, v13, v14
v_max3_u32 v58, v58, v15, v16
v_max3_u32 v58, v58, v17, v18
v_max3_u32 v58, v58, v19, v20
v_max3_u32 v58, v58, v21, v22
v_max_u32 v58, v58, v23
v_cmp_eq_u32 vcc, -1, v58
v_smfmac_f32_16x16x64_bf16 v[24:27], v[8:11], a[0:7], v7
s_cbranch_vccnz L_AAF
L_AAOK:
v_smfmac_f32_16x16x64_bf16 v[24:27], v[12:15], a[8:15], v7
v_smfmac_f32_16x16x64_bf16 v[24:27], v[16:19], a[16:23], v7
v_smfmac_f32_16x16x64_bf16 v[24:27], v[20:23], a[24:31], v7
v_smfmac_f32_16x16x64_bf16 v[28:31], v[8:11], a[32:39], v7
v_smfmac_f32_16x16x64_bf16 v[28:31], v[12:15], a[40:47], v7
v_smfmac_f32_16x16x64_bf16 v[28:31], v[16:19], a[48:55], v7
v_add_f32_dpp v56, v24, v26 quad_perm:[0,1,2,3] row_mask:1 bank_mask:0xf
v_smfmac_f32_16x16x64_bf16 v[28:31], v[20:23], a[56:63], v7
v_add_f32_dpp v57, v25, v27 quad_perm:[0,1,2,3] row_mask:1 bank_mask:0xf
v_smfmac_f32_16x16x64_bf16 v[32:35], v[8:11], a[64:71], v7
v_smfmac_f32_16x16x64_bf16 v[32:35], v[12:15], a[72:79], v7
v_smfmac_f32_16x16x64_bf16 v[32:35], v[16:19], a[80:87], v7
v_add_f32_dpp v56, v28, v30 quad_perm:[0,1,2,3] row_mask:2 bank_mask:0xf
v_smfmac_f32_16x16x64_bf16 v[32:35], v[20:23], a[88:95], v7
v_add_f32_dpp v57, v29, v31 quad_perm:[0,1,2,3] row_mask:2 bank_mask:0xf
v_smfmac_f32_16x16x64_bf16 v[36:39], v[8:11], a[96:103], v7
v_smfmac_f32_16x16x64_bf16 v[36:39], v[12:15], a[104:111], v7
v_smfmac_f32_16x16x64_bf16 v[36:39], v[16:19], a[112:119], v7
v_add_f32_dpp v56, v32, v34 quad_perm:[0,1,2,3] row_mask:4 bank_mask:0xf
v_smfmac_f32_16x16x64_bf16 v[36:39], v[20:23], a[120:127], v7
v_add_f32_dpp v57, v33, v35 quad_perm:[0,1,2,3] row_mask:4 bank_mask:0xf
L_KJ:
s_cmp_lt_u32 s55, s56
s_cbranch_scc1 L_pn_1
L_pnd_2:
v_bfe_u32 v24, v0, 4, 2
v_lshlrev_b32 v24, 3, v24
v_add_u32 v24, 151552, v24
s_add_u32 s71, s72, s90
s_nop 0
v_add_f32_dpp v56, v36, v38 quad_perm:[0,1,2,3] row_mask:8 bank_mask:0xf
v_add_f32_dpp v57, v37, v39 quad_perm:[0,1,2,3] row_mask:8 bank_mask:0xf
s_nop 0
v_max_f32_dpp v58, v56, v56 quad_perm:[1,0,3,2] row_mask:0xf bank_mask:0xf
v_max_f32_dpp v59, v57, v57 quad_perm:[1,0,3,2] row_mask:0xf bank_mask:0xf
s_cmp_lt_u32 s66, 2
v_max_f32_dpp v58, v58, v58 quad_perm:[2,3,0,1] row_mask:0xf bank_mask:0xf
v_max_f32_dpp v59, v59, v59 quad_perm:[2,3,0,1] row_mask:0xf bank_mask:0xf
v_lshl_add_u32 v25, v0, 6, s91
v_max_f32_dpp v58, v58, v58 row_half_mirror row_mask:0xf bank_mask:0xf
v_max_f32_dpp v59, v59, v59 row_half_mirror row_mask:0xf bank_mask:0xf
s_nop 0
v_max_f32_dpp v58, v58, v58 row_mirror row_mask:0xf bank_mask:0xf
v_max_f32_dpp v59, v59, v59 row_mirror row_mask:0xf bank_mask:0xf
s_nop 0
v_max_f32_dpp v58, v58, v58 row_bcast:15 row_mask:0xa bank_mask:0xf
v_max_f32_dpp v59, v59, v59 row_bcast:15 row_mask:0xa bank_mask:0xf
s_nop 0
v_max_f32_dpp v58, v58, v58 row_bcast:31 row_mask:0xc bank_mask:0xf
v_max_f32_dpp v59, v59, v59 row_bcast:31 row_mask:0xc bank_mask:0xf
v_readlane_b32 s75, v58, 63
v_readlane_b32 s76, v59, 63
s_mov_b32 exec_lo, 0
s_mov_b32 exec_hi, 0x80000000
ds_write_b64 v61, v[58:59]
s_mov_b64 exec, -1
v_subrev_f32 v56, s75, v56
v_subrev_f32 v57, s76, v57
v_exp_f32 v56, v56
v_exp_f32 v57, v57
s_nop 0
v_cvt_pk_bf16_f32 v60, v56, v57
ds_write_b16 v121, v60
ds_write_b16_d16_hi v121, v60 offset:16
v_add_f32_dpp v56, v56, v56 quad_perm:[1,0,3,2] row_mask:0xf bank_mask:0xf
v_add_f32_dpp v57, v57, v57 quad_perm:[1,0,3,2] row_mask:0xf bank_mask:0xf
s_cbranch_scc1 L_VEARLY
s_waitcnt vmcnt(0)
L_VB:
v_add_f32_dpp v56, v56, v56 quad_perm:[2,3,0,1] row_mask:0xf bank_mask:0xf
v_add_f32_dpp v57, v57, v57 quad_perm:[2,3,0,1] row_mask:0xf bank_mask:0xf
v_cndmask_b32 v27, v58, v59, s[8:9]
v_add_f32_dpp v56, v56, v56 row_half_mirror row_mask:0xf bank_mask:0xf
v_add_f32_dpp v57, v57, v57 row_half_mirror row_mask:0xf bank_mask:0xf
v_min_u32 v27, -2, v27
v_add_f32_dpp v56, v56, v56 row_mirror row_mask:0xf bank_mask:0xf
v_add_f32_dpp v57, v57, v57 row_mirror row_mask:0xf bank_mask:0xf
s_waitcnt lgkmcnt(0)
s_barrier
ds_read_b128 v[8:11], v62 offset:0
ds_read_b128 v[12:15], v62 offset:1024
ds_read_b128 v[16:19], v62 offset:2048
ds_read_b128 v[20:23], v62 offset:3072
ds_read_b64 v[28:29], v24
ds_read_b64 v[36:37], v63
v_add_f32_dpp v56, v56, v56 row_bcast:15 row_mask:0xa bank_mask:0xf
v_add_f32_dpp v57, v57, v57 row_bcast:15 row_mask:0xa bank_mask:0xf
s_mov_b32 s56, 128
v_add_f32_dpp v56, v56, v56 row_bcast:31 row_mask:0xc bank_mask:0xf
v_add_f32_dpp v57, v57, v57 row_bcast:31 row_mask:0xc bank_mask:0xf
s_min_u32 s57, s59, s56
v_cndmask_b32 v26, v56, v57, s[8:9]
v_min_u32 v26, -2, v26
buffer_store_dwordx2 v[26:27], v25, s[40:43], s71 offen
buffer_store_dwordx2 v[26:27], v25, s[4:7], s71 offen sc1
s_waitcnt lgkmcnt(5)
v_smfmac_f32_16x16x64_bf16 v[40:43], v[8:11], v[128:135], v7
s_waitcnt lgkmcnt(4)
v_smfmac_f32_16x16x64_bf16 v[40:43], v[12:15], v[160:167], v7
s_waitcnt lgkmcnt(0)
v_smfmac_f32_16x16x64_bf16 v[40:43], v[16:19], v[192:199], v7
v_max_f32_dpp v28, v28, v28 quad_perm:[1,0,3,2] row_mask:0xf bank_mask:0xf
v_smfmac_f32_16x16x64_bf16 v[40:43], v[20:23], v[224:231], v7
v_max_f32_dpp v29, v29, v29 quad_perm:[1,0,3,2] row_mask:0xf bank_mask:0xf
v_smfmac_f32_16x16x64_bf16 v[48:51], v[8:11], v[144:151], v7
v_max_f32_dpp v28, v28, v28 quad_perm:[2,3,0,1] row_mask:0xf bank_mask:0xf
v_smfmac_f32_16x16x64_bf16 v[48:51], v[12:15], v[176:183], v7
v_max_f32_dpp v29, v29, v29 quad_perm:[2,3,0,1] row_mask:0xf bank_mask:0xf
v_smfmac_f32_16x16x64_bf16 v[48:51], v[16:19], v[208:215], v7
v_sub_f32 v38, v36, v28
v_smfmac_f32_16x16x64_bf16 v[48:51], v[20:23], v[240:247], v7
v_sub_f32 v39, v37, v29
v_smfmac_f32_16x16x64_bf16 v[44:47], v[8:11], v[136:143], v7
v_exp_f32 v38, v38
v_smfmac_f32_16x16x64_bf16 v[44:47], v[12:15], v[168:175], v7
v_exp_f32 v39, v39
v_smfmac_f32_16x16x64_bf16 v[44:47], v[16:19], v[200:207], v7
v_add_f32 v40, v40, v42
v_smfmac_f32_16x16x64_bf16 v[44:47], v[20:23], v[232:239], v7
v_add_f32 v41, v41, v43
v_smfmac_f32_16x16x64_bf16 v[52:55], v[8:11], v[152:159], v7
v_mul_f32 v40, v40, v38
v_smfmac_f32_16x16x64_bf16 v[52:55], v[12:15], v[184:191], v7
v_mul_f32 v41, v41, v39
v_smfmac_f32_16x16x64_bf16 v[52:55], v[16:19], v[216:223], v7
v_add_f32 v48, v48, v50
v_smfmac_f32_16x16x64_bf16 v[52:55], v[20:23], v[248:255], v7
v_add_f32 v49, v49, v51
L_POST:
buffer_load_dwordx4 v[56:59], v124, s[44:47], s72 offen sc1
buffer_load_dwordx4 v[60:63], v124, s[44:47], s72 offen offset:512 sc1
v_pk_mul_f32 v[48:49], v[48:49], v[38:39]
v_pk_add_f32 v[44:45], v[44:45], v[46:47]
v_pk_mul_f32 v[44:45], v[44:45], v[38:39]
v_permlane32_swap_b32 v40, v48
v_permlane32_swap_b32 v41, v49
v_pk_add_f32 v[52:53], v[52:53], v[54:55]
v_pk_mul_f32 v[52:53], v[52:53], v[38:39]
v_pk_add_f32 v[40:41], v[40:41], v[48:49]
s_nop 0
v_permlane32_swap_b32 v44, v52
v_permlane32_swap_b32 v45, v53
v_pk_add_f32 v[44:45], v[44:45], v[52:53]
s_nop 1
v_permlane16_swap_b32 v40, v44
v_permlane16_swap_b32 v41, v45
v_pk_add_f32 v[40:41], v[40:41], v[44:45]
v_cvt_pk_bf16_f32 v40, v40, v41
s_nop 1
v_mov_b32_dpp v41, v40 quad_perm:[1,0,3,2] row_mask:0xf bank_mask:0xf
v_perm_b32 v40, v40, v41, v127
v_min_u32 v40, -2, v40
buffer_store_dword v40, v122, s[40:43], s70 offen
buffer_store_dword v40, v122, s[4:7], s70 offen sc1
s_cmp_ge_u32 s35, 28
s_cbranch_scc1 L_NOO0
s_mov_b32 s65, 0
s_cmp_lt_u32 s55, 128
s_cbranch_scc1 L_OS0
s_waitcnt vmcnt(2)
L_OSC:
v_max3_u32 v40, v56, v58, v60
v_max3_u32 v40, v40, v62, v57
v_max3_u32 v40, v40, v59, v61
v_max_u32 v40, v40, v63
v_cmp_eq_u32 vcc, -1, v40
v_max3_f32 v41, v57, v59, v61
s_cbranch_vccnz L_OSF
v_max_f32 v41, v41, v63
s_nop 1
v_max_f32_dpp v42, v41, v41 quad_perm:[1,0,3,2] row_mask:0xf bank_mask:0xf
s_nop 1
v_max_f32_dpp v42, v42, v42 quad_perm:[2,3,0,1] row_mask:0xf bank_mask:0xf
v_sub_f32 v43, v57, v42
v_sub_f32 v44, v59, v42
v_sub_f32 v45, v61, v42
v_sub_f32 v46, v63, v42
v_sub_f32 v41, v41, v42
v_exp_f32 v43, v43
v_exp_f32 v44, v44
v_exp_f32 v45, v45
v_exp_f32 v46, v46
v_exp_f32 v41, v41
v_mul_f32 v43, v43, v56
v_fmac_f32 v43, v44, v58
v_fmac_f32 v43, v45, v60
v_fmac_f32 v43, v46, v62
s_nop 1
v_add_f32_dpp v43, v43, v43 quad_perm:[1,0,3,2] row_mask:0xf bank_mask:0xf
s_nop 1
v_add_f32_dpp v43, v43, v43 quad_perm:[2,3,0,1] row_mask:0xf bank_mask:0xf
v_rcp_f32 v43, v43
s_nop 0
v_mul_f32 v5, v41, v43
s_cmp_lt_u32 s55, 128
s_cbranch_scc1 L_OCS
s_cmp_lg_u32 s65, 0
s_cbranch_scc1 L_OR
s_waitcnt vmcnt(0)
buffer_load_dwordx4 v[8:11], v123, s[44:47], s70 offen offset:0 sc1
buffer_load_dwordx4 v[12:15], v123, s[44:47], s70 offen offset:2048 sc1
buffer_load_dwordx4 v[16:19], v123, s[44:47], s70 offen offset:1024 sc1
buffer_load_dwordx4 v[20:23], v123, s[44:47], s70 offen offset:3072 sc1
s_bitcmp1_b32 s66, 0
s_cbranch_scc1 L_OWB0
v_mov_b32 v24, v80
v_mov_b32 v25, v81
v_mov_b32 v26, v82
v_mov_b32 v27, v83
v_mov_b32 v28, v84
v_mov_b32 v29, v85
v_mov_b32 v30, v86
v_mov_b32 v31, v87
v_mov_b32 v32, v88
v_mov_b32 v33, v89
v_mov_b32 v34, v90
v_mov_b32 v35, v91
v_mov_b32 v36, v92
v_mov_b32 v37, v93
v_mov_b32 v38, v94
v_mov_b32 v39, v95
L_OWJ0:
L_OR:
buffer_load_dwordx4 v[8:11], v123, s[44:47], s70 offen offset:0 sc1
buffer_load_dwordx4 v[12:15], v123, s[44:47], s70 offen offset:2048 sc1
buffer_load_dwordx4 v[16:19], v123, s[44:47], s70 offen offset:1024 sc1
buffer_load_dwordx4 v[20:23], v123, s[44:47], s70 offen offset:3072 sc1
s_waitcnt vmcnt(6)
v_max3_u32 v48, v8, v9, v10
v_max3_u32 v48, v48, v11, v12
v_max3_u32 v48, v48, v13, v14
v_max_u32 v48, v48, v15
v_cmp_eq_u32 vcc, -1, v48
v_mfma_f32_16x16x32_bf16 v[40:43], v[8:11], v[24:27], 0
s_nop 1
s_mov_b64 s[78:79], vcc
v_mfma_f32_16x16x32_bf16 v[40:43], v[12:15], v[32:35], v[40:43]
v_mfma_f32_16x16x32_bf16 v[44:47], v[8:11], v[28:31], 0
v_mfma_f32_16x16x32_bf16 v[44:47], v[12:15], v[36:39], v[44:47]
s_waitcnt vmcnt(4)
v_max3_u32 v52, v16, v17, v18
v_max3_u32 v52, v52, v19, v20
v_max3_u32 v52, v52, v21, v22
v_max_u32 v52, v52, v23
v_cmp_eq_u32 vcc, -1, v52
v_mfma_f32_16x16x32_bf16 v[48:51], v[16:19], v[24:27], 0
s_nop 1
s_or_b64 vcc, vcc, s[78:79]
s_cbranch_scc1 L_OF
L_OOK:
v_mfma_f32_16x16x32_bf16 v[48:51], v[20:23], v[32:35], v[48:51]
v_mul_f32_dpp v24, v5, v40 row_newbcast:0 row_mask:0xf bank_mask:0xf
v_mul_f32_dpp v25, v5, v44 row_newbcast:0 row_mask:0xf bank_mask:0xf
v_mfma_f32_16x16x32_bf16 v[52:55], v[16:19], v[28:31], 0
v_fmac_f32_dpp v24, v5, v41 row_newbcast:1 row_mask:0xf bank_mask:0xf
v_fmac_f32_dpp v25, v5, v45 row_newbcast:1 row_mask:0xf bank_mask:0xf
v_mfma_f32_16x16x32_bf16 v[52:55], v[20:23], v[36:39], v[52:55]
v_fmac_f32_dpp v24, v5, v42 row_newbcast:2 row_mask:0xf bank_mask:0xf
v_fmac_f32_dpp v25, v5, v46 row_newbcast:2 row_mask:0xf bank_mask:0xf
v_mul_f32_dpp v26, v5, v48 row_newbcast:4 row_mask:0xf bank_mask:0xf
v_mul_f32_dpp v28, v5, v50 row_newbcast:6 row_mask:0xf bank_mask:0xf
v_fmac_f32_dpp v24, v5, v43 row_newbcast:3 row_mask:0xf bank_mask:0xf
v_fmac_f32_dpp v25, v5, v47 row_newbcast:3 row_mask:0xf bank_mask:0xf
v_fmac_f32_dpp v26, v5, v49 row_newbcast:5 row_mask:0xf bank_mask:0xf
v_fmac_f32_dpp v28, v5, v51 row_newbcast:7 row_mask:0xf bank_mask:0xf
v_mul_f32_dpp v27, v5, v52 row_newbcast:4 row_mask:0xf bank_mask:0xf
v_mul_f32_dpp v29, v5, v54 row_newbcast:6 row_mask:0xf bank_mask:0xf
ds_write2st64_b32 v114, v24, v25 offset0:0 offset1:1
v_fmac_f32_dpp v27, v5, v53 row_newbcast:5 row_mask:0xf bank_mask:0xf
v_fmac_f32_dpp v29, v5, v55 row_newbcast:7 row_mask:0xf bank_mask:0xf
v_pk_add_f32 v[26:27], v[26:27], v[28:29]
ds_write2st64_b32 v114, v26, v27 offset0:2 offset1:3
s_waitcnt lgkmcnt(0)
s_barrier
ds_read_b32 v28, v125
ds_read_b32 v29, v125 offset:2112
ds_read_b32 v30, v125 offset:4224
ds_read_b32 v31, v125 offset:6336
s_waitcnt lgkmcnt(0)
v_pk_add_f32 v[28:29], v[28:29], v[30:31]
v_add_f32 v28, v28, v29
v_min_u32 v28, -2, v28
buffer_store_dword v28, v126, s[44:47], s73 offen sc1
L_NOO:
s_add_u32 s74, s74, 425984
s_mov_b32 s67, s74
s_add_u32 s71, s95, 4096
s_cmp_eq_u32 s66, 3
s_cbranch_scc1 L_LAST
s_cmp_lg_u32 s52, 1
s_cbranch_scc1 L_NOTOUCH
s_mul_i32 s77, s35, 1664
s_add_u32 s77, s77, s74
v_lshlrev_b32 v32, 3, v0
s_mov_b64 exec, 0x1fff
buffer_load_dword v63, v32, s[44:47], s77 offen sc1
s_mov_b64 exec, -1
L_NOTOUCH:
s_mov_b32 s75, s66
s_mov_b32 s76, 0
s_cmp_ge_u32 s35, 28
s_cselect_b32 s77, 7, s52
s_cmp_eq_u32 s66, 0
s_cbranch_scc1 L_X0
s_cmp_lg_u32 s77, 0
s_cbranch_scc1 L_NOX
L_XGO:
s_waitcnt vmcnt(0)
L_XPOLL:
buffer_load_dwordx4 v[24:27], v0, s[44:47], s95 offen offset:0 sc1
buffer_load_dwordx4 v[28:31], v0, s[44:47], s95 offen offset:1024 sc1
buffer_load_dwordx4 v[32:35], v0, s[44:47], s95 offen offset:2048 sc1
buffer_load_dwordx4 v[36:39], v0, s[44:47], s95 offen offset:3072 sc1
buffer_load_dwordx4 v[40:43], v0, s[44:47], s71 offen offset:0 sc1
buffer_load_dwordx4 v[44:47], v0, s[44:47], s71 offen offset:1024 sc1
buffer_load_dwordx4 v[48:51], v0, s[44:47], s71 offen offset:2048 sc1
buffer_load_dwordx4 v[52:55], v0, s[44:47], s71 offen offset:3072 sc1
v_lshlrev_b32 v58, 16, v1
v_and_b32 v59, 0xffff0000, v1
s_cmp_eq_u32 s75, 2
s_cbranch_scc1 L_PRELOADA
L_PRELDA:
s_waitcnt vmcnt(6)
v_pk_add_f32 v[60:61], v[24:25], v[28:29]
v_pk_add_f32 v[62:63], v[26:27], v[30:31]
s_waitcnt vmcnt(5)
v_pk_add_f32 v[60:61], v[60:61], v[32:33]
v_pk_add_f32 v[62:63], v[62:63], v[34:35]
s_waitcnt vmcnt(4)
v_pk_add_f32 v[60:61], v[60:61], v[36:37]
v_pk_add_f32 v[62:63], v[62:63], v[38:39]
s_waitcnt vmcnt(3)
v_pk_add_f32 v[60:61], v[60:61], v[40:41]
v_pk_add_f32 v[62:63], v[62:63], v[42:43]
s_waitcnt vmcnt(2)
v_pk_add_f32 v[60:61], v[60:61], v[44:45]
v_pk_add_f32 v[62:63], v[62:63], v[46:47]
s_waitcnt vmcnt(1)
v_pk_add_f32 v[60:61], v[60:61], v[48:49]
v_pk_add_f32 v[62:63], v[62:63], v[50:51]
s_waitcnt vmcnt(0)
v_pk_add_f32 v[60:61], v[60:61], v[52:53]
v_pk_add_f32 v[62:63], v[62:63], v[54:55]
L_XSUM:
s_nop 1
v_permlane32_swap_b32 v60, v62
v_permlane32_swap_b32 v61, v63
v_pk_add_f32 v[60:61], v[60:61], v[62:63]
v_cmp_u_f32 vcc, v60, v61
v_cvt_pk_bf16_f32 v62, v60, v61
s_cbranch_vccnz L_XNAN
L_XOK:
v_lshlrev_b32 v60, 16, v62
v_and_b32 v61, 0xffff0000, v62
v_pk_add_f32 v[58:59], v[58:59], v[60:61]
v_cvt_pk_bf16_f32 v1, v58, v59
v_min_u32 v57, -2, v1
buffer_store_dword v57, v113, s[40:43], s67 offen
buffer_store_dword v57, v113, s[4:7], s67 offen sc1
s_cmp_eq_u32 s66, 3
s_cbranch_scc1 L_END
s_branch L_NODR2
L_NOX:
s_cmp_eq_u32 s75, 2
s_cbranch_scc1 L_PRELOADB
L_PRELDB:
L_NODR2:
s_add_u32 s48, s32, s74
s_addc_u32 s49, s33, 0
s_add_u32 s69, s74, 0x2000
s_add_u32 s70, s74, 0x4000
s_add_u32 s72, s74, 0xC000
s_add_u32 s73, s73, 0x38000
s_add_u32 s95, s95, 0x38000
s_add_u32 s66, s66, 1
s_cmp_eq_u32 s66, 2
s_cbranch_scc1 L_QAP
s_branch L_QBP
L_END:
L_EXIT:
s_endpgm
L_PUMP:
s_cmp_ge_u32 s55, s57
s_cbranch_scc1 L_PSPEC
L_PGEN:
s_lshr_b32 s64, s54, 7
s_mov_b32 m0, s54
s_and_b32 s64, s64, 0xc0
v_xor_b32 v5, s64, v3
buffer_load_dwordx4 v5, s[36:39], m0 offen nt lds
s_add_u32 m0, s54, 4096
v_xor_b32 v5, 32, v5
s_add_u32 s54, s54, 8192
buffer_load_dwordx4 v5, s[36:39], m0 offen nt lds
s_add_u32 s55, s55, 2
L_PRET:
s_setpc_b64 s[60:61]
L_Q0:
s_waitcnt vmcnt(18)
s_call_b64 s[60:61], L_PUMP
s_waitcnt vmcnt(18)
s_call_b64 s[60:61], L_PUMP
s_waitcnt vmcnt(18)
s_call_b64 s[60:61], L_PUMP
s_waitcnt vmcnt(18)
s_call_b64 s[60:61], L_PUMP
s_waitcnt vmcnt(8)
s_cmp_lt_u32 s55, s56
s_cbranch_scc1 L_dr_3
s_waitcnt vmcnt(0)
L_dr_3:
s_call_b64 s[60:61], L_PUMP
s_call_b64 s[60:61], L_PUMP
s_call_b64 s[60:61], L_PUMP
s_barrier
s_cmp_lg_u32 s52, 0
s_cbranch_scc1 L_ARR
s_mov_b64 exec, 1
global_atomic_add v29, v28, s[30:31] sc1
s_mov_b64 exec, -1
L_ARR:
s_not_b64 exec, s[86:87]
v_mov_b32 v8, 0x3f803f80
v_mov_b32 v9, 0x3f803f80
v_mov_b32 v10, 0x3f803f80
v_mov_b32 v11, 0x3f803f80
v_mov_b32 v12, 0x3f803f80
v_mov_b32 v13, 0x3f803f80
v_mov_b32 v14, 0x3f803f80
v_mov_b32 v15, 0x3f803f80
v_mov_b32 v16, 0x3f803f80
v_mov_b32 v17, 0x3f803f80
v_mov_b32 v18, 0x3f803f80
v_mov_b32 v19, 0x3f803f80
v_mov_b32 v20, 0x3f803f80
v_mov_b32 v21, 0x3f803f80
v_mov_b32 v22, 0x3f803f80
v_mov_b32 v23, 0x3f803f80
s_mov_b64 exec, -1
s_mov_b64 exec, s[86:87]
v_mov_b32 v8, v40
v_mov_b32 v9, v41
v_mov_b32 v10, v42
v_mov_b32 v11, v43
v_mov_b32 v12, v44
v_mov_b32 v13, v45
v_mov_b32 v14, v46
v_mov_b32 v15, v47
v_mov_b32 v16, v48
v_mov_b32 v17, v49
v_mov_b32 v18, v50
v_mov_b32 v19, v51
v_mov_b32 v20, v52
v_mov_b32 v21, v53
v_mov_b32 v22, v54
v_mov_b32 v23, v55
s_mov_b64 exec, -1
v_lshrrev_b32 v5, 8, v0
v_lshlrev_b32 v5, 8, v5
v_bfe_u32 v64, v0, 4, 4
v_lshl_add_u32 v5, v64, 3, v5
s_lshl_b32 s77, s52, 12
s_add_u32 s77, s77, 131072
v_add_u32 v5, s77, v5
ds_read_b64_tr_b16 v[64:65], v5 offset:0
ds_read_b64_tr_b16 v[66:67], v5 offset:128
ds_read_b64_tr_b16 v[68:69], v5 offset:1024
ds_read_b64_tr_b16 v[70:71], v5 offset:1152
ds_read_b64_tr_b16 v[72:73], v5 offset:2048
ds_read_b64_tr_b16 v[74:75], v5 offset:2176
ds_read_b64_tr_b16 v[76:77], v5 offset:3072
ds_read_b64_tr_b16 v[78:79], v5 offset:3200
s_waitcnt lgkmcnt(0)
s_call_b64 s[60:61], L_PUMP
s_call_b64 s[60:61], L_PUMP
v_mfma_f32_16x16x32_bf16 v[28:31], v[8:11], v[8:11], 0
s_branch L_QAOK
L_QAF:
s_sub_u32 s68, s68, 1
s_cbranch_scc1 L_END
s_branch L_QAR
L_QBP:
s_cmp_lt_u32 s66, 2
s_cbranch_scc1 L_QBS0
s_waitcnt vmcnt(0) lgkmcnt(0)
s_barrier
s_mov_b64 exec, s[86:87]
buffer_load_dwordx4 v[8:11], v112, s[48:51], 0 offen offset:0 sc1
buffer_load_dwordx4 v[12:15], v112, s[48:51], 0 offen offset:512 sc1
buffer_load_dwordx4 v[16:19], v112, s[48:51], 0 offen offset:1024 sc1
buffer_load_dwordx4 v[20:23], v112, s[48:51], 0 offen offset:1536 sc1
s_mov_b64 exec, -1
s_not_b64 exec, s[86:87]
v_mov_b32 v8, 0x3f803f80
v_mov_b32 v9, 0x3f803f80
v_mov_b32 v10, 0x3f803f80
v_mov_b32 v11, 0x3f803f80
v_mov_b32 v12, 0x3f803f80
v_mov_b32 v13, 0x3f803f80
v_mov_b32 v14, 0x3f803f80
v_mov_b32 v15, 0x3f803f80
v_mov_b32 v16, 0x3f803f80
v_mov_b32 v17, 0x3f803f80
v_mov_b32 v18, 0x3f803f80
v_mov_b32 v19, 0x3f803f80
v_mov_b32 v20, 0x3f803f80
v_mov_b32 v21, 0x3f803f80
v_mov_b32 v22, 0x3f803f80
v_mov_b32 v23, 0x3f803f80
s_mov_b64 exec, -1
L_QBR:
s_mov_b64 exec, s[86:87]
buffer_load_dwordx4 v[8:11], v112, s[48:51], 0 offen offset:0 sc1
buffer_load_dwordx4 v[12:15], v112, s[48:51], 0 offen offset:512 sc1
buffer_load_dwordx4 v[16:19], v112, s[48:51], 0 offen offset:1024 sc1
buffer_load_dwordx4 v[20:23], v112, s[48:51], 0 offen offset:1536 sc1
s_mov_b64 exec, -1
s_waitcnt vmcnt(4)
L_QBC:
v_max3_u32 v32, v8, v9, v10
v_max3_u32 v32, v32, v11, v12
v_max3_u32 v32, v32, v13, v14
v_max3_u32 v32, v32, v15, v16
v_max3_u32 v32, v32, v17, v18
v_max3_u32 v32, v32, v19, v20
v_max3_u32 v32, v32, v21, v22
v_max_u32 v32, v32, v23
v_cmp_eq_u32 vcc, -1, v32
v_mfma_f32_16x16x32_bf16 v[28:31], v[8:11], v[8:11], 0
s_cbranch_vccnz L_QBF
L_QBOK:
v_mfma_f32_16x16x32_bf16 v[24:27], v[8:11], v[96:99], 0
v_mfma_f32_16x16x32_bf16 v[28:31], v[12:15], v[12:15], v[28:31]
v_mfma_f32_16x16x32_bf16 v[24:27], v[12:15], v[100:103], v[24:27]
v_mfma_f32_16x16x32_bf16 v[28:31], v[16:19], v[16:19], v[28:31]
v_mfma_f32_16x16x32_bf16 v[24:27], v[16:19], v[104:107], v[24:27]
v_mfma_f32_16x16x32_bf16 v[28:31], v[20:23], v[20:23], v[28:31]
v_mfma_f32_16x16x32_bf16 v[24:27], v[20:23], v[108:111], v[24:27]
s_branch L_QJ
L_INIT:
s_cmp_eq_u32 s66, 0
s_cbranch_scc1 L_INIT0
buffer_load_dword v1, v113, s[48:51], 0 offen sc1
L_pu_4:
s_cmp_ge_u32 s55, 103
s_cbranch_scc1 L_pud_5
s_waitcnt vmcnt(6)
s_call_b64 s[60:61], L_PUMP
s_branch L_pu_4
L_pud_5:
s_branch L_INITD
L_INIT0:
L_pu_6:
s_cmp_ge_u32 s55, 26
s_cbranch_scc1 L_pud_7
s_waitcnt vmcnt(8)
s_call_b64 s[60:61], L_PUMP
s_branch L_pu_6
L_pud_7:
L_pu_8:
s_cmp_ge_u32 s55, 42
s_cbranch_scc1 L_pud_9
s_waitcnt vmcnt(6)
s_call_b64 s[60:61], L_PUMP
s_branch L_pu_8
L_pud_9:
v_lshlrev_b32 v41, 1, v0
v_mov_b32 v42, 151616
s_cmp_lg_u32 s52, 0
s_cbranch_scc1 L_IWAIT
L_IPOLL:
s_mov_b64 exec, 0xff
global_load_dword v8, v41, s[30:31] sc1
s_mov_b64 exec, -1
s_waitcnt vmcnt(14)
s_call_b64 s[60:61], L_PUMP
s_waitcnt vmcnt(14)
s_call_b64 s[60:61], L_PUMP
s_waitcnt vmcnt(14)
s_call_b64 s[60:61], L_PUMP
s_waitcnt vmcnt(14)
s_call_b64 s[60:61], L_PUMP
s_waitcnt vmcnt(8)
s_cmp_lt_u32 s55, s56
s_cbranch_scc1 L_dr_10
s_waitcnt vmcnt(0)
L_dr_10:
s_mov_b64 exec, 0xff
v_and_b32 v9, 63, v8
v_cmp_ne_u32 vcc, 32, v9
s_mov_b64 exec, -1
s_cbranch_vccnz L_IFAIL
v_readlane_b32 s77, v8, s34
s_nop 2
s_cmp_eq_u32 s77, s94
s_cselect_b32 s77, 2, 1
v_mov_b32 v9, s77
ds_write_b32 v42, v9
s_branch L_IGOT
L_IFAIL:
s_sub_u32 s68, s68, 1
s_cbranch_scc1 L_END
s_branch L_IPOLL
L_IWAIT:
s_waitcnt vmcnt(6)
s_call_b64 s[60:61], L_PUMP
ds_read_b32 v9, v42
s_sub_u32 s68, s68, 1
s_cbranch_scc1 L_END
s_waitcnt lgkmcnt(0)
v_readfirstlane_b32 s77, v9
s_nop 2
s_cmp_eq_u32 s77, 0
s_cbranch_scc1 L_IWAIT
L_IGOT:
s_mov_b32 s82, s77
L_pu_11:
s_cmp_ge_u32 s55, 39
s_cbranch_scc1 L_pud_12
s_waitcnt vmcnt(6)
s_call_b64 s[60:61], L_PUMP
s_branch L_pu_11
L_pud_12:
L_pu_13:
s_cmp_ge_u32 s55, 48
s_cbranch_scc1 L_pud_14
s_waitcnt vmcnt(6)
s_call_b64 s[60:61], L_PUMP
s_branch L_pu_13
L_pud_14:
s_waitcnt vmcnt(8)
s_waitcnt lgkmcnt(0)
s_barrier
s_call_b64 s[62:63], L_MOVEV0
s_mov_b32 s77, s82
s_cmp_eq_u32 s77, 2
s_cselect_b32 s42, 2686976, 0
s_cselect_b32 s6, 0, 2686976
s_cmp_lg_u32 s52, 1
s_cbranch_scc1 L_INITD
s_mul_i32 s77, s35, 1664
s_add_u32 s77, s77, s74
v_lshlrev_b32 v41, 3, v0
s_mov_b64 exec, 0x1fff
buffer_load_dword v9, v41, s[44:47], s77 offen sc1
s_mov_b64 exec, -1
s_branch L_INITD
L_AAF:
s_nop 7
v_mov_b32 v24, 0
v_mov_b32 v25, 0
v_mov_b32 v26, 0
v_mov_b32 v27, 0
s_sub_u32 s68, s68, 1
s_cbranch_scc1 L_END
s_branch L_AAR
L_AAS0:
s_mov_b32 s65, 2
v_mov_b32 v24, 0
v_mov_b32 v25, 0
v_mov_b32 v26, 0
v_mov_b32 v27, 0
v_mov_b32 v28, 0
v_mov_b32 v29, 0
v_mov_b32 v30, 0
v_mov_b32 v31, 0
v_mov_b32 v32, 0
v_mov_b32 v33, 0
v_mov_b32 v34, 0
v_mov_b32 v35, 0
v_mov_b32 v36, 0
v_mov_b32 v37, 0
v_mov_b32 v38, 0
v_mov_b32 v39, 0
v_mov_b32 v40, 0
v_mov_b32 v41, 0
v_mov_b32 v42, 0
v_mov_b32 v43, 0
v_mov_b32 v44, 0
v_mov_b32 v45, 0
v_mov_b32 v46, 0
v_mov_b32 v47, 0
v_mov_b32 v48, 0
v_mov_b32 v49, 0
v_mov_b32 v50, 0
v_mov_b32 v51, 0
v_mov_b32 v52, 0
v_mov_b32 v53, 0
v_mov_b32 v54, 0
v_mov_b32 v55, 0
s_branch L_AAS1
L_AALC:
v_and_b32 v59, 0x3ff, v120
v_add_u32 v59, 160768, v59
ds_read_b128 v[8:11], v59 offset:0
ds_read_b128 v[12:15], v59 offset:256
ds_read_b128 v[16:19], v59 offset:512
ds_read_b128 v[20:23], v59 offset:768
s_waitcnt lgkmcnt(0)
v_max3_u32 v58, v8, v9, v10
v_max3_u32 v58, v58, v11, v12
v_max3_u32 v58, v58, v13, v14
v_max3_u32 v58, v58, v15, v16
v_max3_u32 v58, v58, v17, v18
v_max3_u32 v58, v58, v19, v20
v_max3_u32 v58, v58, v21, v22
v_max_u32 v58, v58, v23
v_cmp_eq_u32 vcc, -1, v58
s_cbranch_vccnz L_AALF
v_smfmac_f32_16x16x64_bf16 v[24:27], v[8:11], a[0:7], v7
s_branch L_AAOK
L_AALF:
s_sub_u32 s68, s68, 1
s_cbranch_scc1 L_END
L_AAS1:
s_mov_b32 m0, 160768
s_nop 0
buffer_load_dwordx4 v60, s[44:47], s69 offen sc1 lds
L_AAS:
s_waitcnt vmcnt(7)
s_call_b64 s[60:61], L_PUMP
s_waitcnt vmcnt(8)
s_cmp_lt_u32 s55, s56
s_cbranch_scc1 L_AAS_w
s_waitcnt vmcnt(0)
s_branch L_AALC
L_AAS_w:
s_sub_u32 s65, s65, 1
s_cbranch_scc0 L_AAS1
s_mov_b32 s65, 0
s_branch L_AALC
L_ABP:
s_cmp_lt_u32 s66, 2
s_cbranch_scc1 L_ABS0
s_waitcnt vmcnt(0)
buffer_load_dwordx4 v[8:11], v120, s[44:47], s69 offen offset:0 sc1
buffer_load_dwordx4 v[12:15], v120, s[44:47], s69 offen offset:256 sc1
buffer_load_dwordx4 v[16:19], v120, s[44:47], s69 offen offset:512 sc1
buffer_load_dwordx4 v[20:23], v120, s[44:47], s69 offen offset:768 sc1
v_mov_b32 v24, 0
v_mov_b32 v25, 0
v_mov_b32 v26, 0
v_mov_b32 v27, 0
v_mov_b32 v28, 0
v_mov_b32 v29, 0
v_mov_b32 v30, 0
v_mov_b32 v31, 0
v_mov_b32 v32, 0
v_mov_b32 v33, 0
v_mov_b32 v34, 0
v_mov_b32 v35, 0
v_mov_b32 v36, 0
v_mov_b32 v37, 0
v_mov_b32 v38, 0
v_mov_b32 v39, 0
v_mov_b32 v40, 0
v_mov_b32 v41, 0
v_mov_b32 v42, 0
v_mov_b32 v43, 0
v_mov_b32 v44, 0
v_mov_b32 v45, 0
v_mov_b32 v46, 0
v_mov_b32 v47, 0
v_mov_b32 v48, 0
v_mov_b32 v49, 0
v_mov_b32 v50, 0
v_mov_b32 v51, 0
v_mov_b32 v52, 0
v_mov_b32 v53, 0
v_mov_b32 v54, 0
v_mov_b32 v55, 0
L_ABR:
buffer_load_dwordx4 v[8:11], v120, s[44:47], s69 offen offset:0 sc1
buffer_load_dwordx4 v[12:15], v120, s[44:47], s69 offen offset:256 sc1
buffer_load_dwordx4 v[16:19], v120, s[44:47], s69 offen offset:512 sc1
buffer_load_dwordx4 v[20:23], v120, s[44:47], s69 offen offset:768 sc1
s_waitcnt vmcnt(4)
L_ABC:
v_max3_u32 v58, v8, v9, v10
v_max3_u32 v58, v58, v11, v12
v_max3_u32 v58, v58, v13, v14
v_max3_u32 v58, v58, v15, v16
v_max3_u32 v58, v58, v17, v18
v_max3_u32 v58, v58, v19, v20
v_max3_u32 v58, v58, v21, v22
v_max_u32 v58, v58, v23
v_cmp_eq_u32 vcc, -1, v58
v_smfmac_f32_16x16x64_bf16 v[24:27], v[8:11], a[128:135], v7
s_cbranch_vccnz L_ABF
L_ABOK:
v_smfmac_f32_16x16x64_bf16 v[24:27], v[12:15], a[136:143], v7
v_smfmac_f32_16x16x64_bf16 v[24:27], v[16:19], a[144:151], v7
v_smfmac_f32_16x16x64_bf16 v[24:27], v[20:23], a[152:159], v7
v_smfmac_f32_16x16x64_bf16 v[28:31], v[8:11], a[160:167], v7
v_smfmac_f32_16x16x64_bf16 v[28:31], v[12:15], a[168:175], v7
v_smfmac_f32_16x16x64_bf16 v[28:31], v[16:19], a[176:183], v7
v_add_f32_dpp v56, v24, v26 quad_perm:[0,1,2,3] row_mask:1 bank_mask:0xf
v_smfmac_f32_16x16x64_bf16 v[28:31], v[20:23], a[184:191], v7
v_add_f32_dpp v57, v25, v27 quad_perm:[0,1,2,3] row_mask:1 bank_mask:0xf
v_smfmac_f32_16x16x64_bf16 v[32:35], v[8:11], a[192:199], v7
v_smfmac_f32_16x16x64_bf16 v[32:35], v[12:15], a[200:207], v7
v_smfmac_f32_16x16x64_bf16 v[32:35], v[16:19], a[208:215], v7
v_add_f32_dpp v56, v28, v30 quad_perm:[0,1,2,3] row_mask:2 bank_mask:0xf
v_smfmac_f32_16x16x64_bf16 v[32:35], v[20:23], a[216:223], v7
v_add_f32_dpp v57, v29, v31 quad_perm:[0,1,2,3] row_mask:2 bank_mask:0xf
v_smfmac_f32_16x16x64_bf16 v[36:39], v[8:11], a[224:231], v7
v_smfmac_f32_16x16x64_bf16 v[36:39], v[12:15], a[232:239], v7
v_smfmac_f32_16x16x64_bf16 v[36:39], v[16:19], a[240:247], v7
v_add_f32_dpp v56, v32, v34 quad_perm:[0,1,2,3] row_mask:4 bank_mask:0xf
v_smfmac_f32_16x16x64_bf16 v[36:39], v[20:23], a[248:255], v7
v_add_f32_dpp v57, v33, v35 quad_perm:[0,1,2,3] row_mask:4 bank_mask:0xf
s_branch L_KJ
L_pn_1:
s_call_b64 s[60:61], L_PUMP
s_branch L_pnd_2
L_VEARLY:
s_cmp_eq_u32 s66, 0
s_cbranch_scc0 L_PROG
L_pu_15:
s_cmp_ge_u32 s55, 56
s_cbranch_scc1 L_pud_16
s_waitcnt vmcnt(6)
s_call_b64 s[60:61], L_PUMP
s_branch L_pu_15
L_pud_16:
s_waitcnt vmcnt(8)
s_waitcnt lgkmcnt(0)
s_barrier
s_mov_b32 s56, 72
s_min_u32 s57, s59, s56
s_call_b64 s[62:63], L_MOVEV1
L_pu_17:
s_cmp_ge_u32 s55, 62
s_cbranch_scc1 L_pud_18
s_waitcnt vmcnt(4)
s_call_b64 s[60:61], L_PUMP
s_branch L_pu_17
L_pud_18:
s_waitcnt vmcnt(6)
s_waitcnt lgkmcnt(0)
s_barrier
s_mov_b32 s56, 80
s_min_u32 s57, s59, s56
s_call_b64 s[62:63], L_MOVEV2
L_pu_19:
s_cmp_ge_u32 s55, 70
s_cbranch_scc1 L_pud_20
s_waitcnt vmcnt(4)
s_call_b64 s[60:61], L_PUMP
s_branch L_pu_19
L_pud_20:
s_waitcnt vmcnt(6)
s_waitcnt lgkmcnt(0)
s_barrier
s_mov_b32 s56, 88
s_min_u32 s57, s59, s56
s_call_b64 s[62:63], L_MOVEV3
s_branch L_VB
L_PROG:
s_call_b64 s[60:61], L_PUMP
v_add_f32_dpp v56, v56, v56 quad_perm:[2,3,0,1] row_mask:0xf bank_mask:0xf
v_add_f32_dpp v57, v57, v57 quad_perm:[2,3,0,1] row_mask:0xf bank_mask:0xf
s_nop 0
v_add_f32_dpp v56, v56, v56 row_half_mirror row_mask:0xf bank_mask:0xf
v_add_f32_dpp v57, v57, v57 row_half_mirror row_mask:0xf bank_mask:0xf
s_nop 0
v_add_f32_dpp v56, v56, v56 row_mirror row_mask:0xf bank_mask:0xf
v_add_f32_dpp v57, v57, v57 row_mirror row_mask:0xf bank_mask:0xf
s_nop 0
v_add_f32_dpp v56, v56, v56 row_bcast:15 row_mask:0xa bank_mask:0xf
v_add_f32_dpp v57, v57, v57 row_bcast:15 row_mask:0xa bank_mask:0xf
s_nop 0
v_add_f32_dpp v56, v56, v56 row_bcast:31 row_mask:0xc bank_mask:0xf
v_add_f32_dpp v57, v57, v57 row_bcast:31 row_mask:0xc bank_mask:0xf
v_cndmask_b32 v27, v58, v59, s[8:9]
v_cndmask_b32 v26, v56, v57, s[8:9]
v_min_u32 v27, -2, v27
v_min_u32 v26, -2, v26
buffer_store_dwordx2 v[26:27], v25, s[40:43], s71 offen
buffer_store_dwordx2 v[26:27], v25, s[4:7], s71 offen sc1
s_waitcnt lgkmcnt(0)
s_barrier
ds_read_b64 v[28:29], v24
ds_read_b64 v[36:37], v63
s_waitcnt lgkmcnt(0)
v_max_f32_dpp v28, v28, v28 quad_perm:[1,0,3,2] row_mask:0xf bank_mask:0xf
v_max_f32_dpp v29, v29, v29 quad_perm:[1,0,3,2] row_mask:0xf bank_mask:0xf
s_nop 0
v_max_f32_dpp v28, v28, v28 quad_perm:[2,3,0,1] row_mask:0xf bank_mask:0xf
v_max_f32_dpp v29, v29, v29 quad_perm:[2,3,0,1] row_mask:0xf bank_mask:0xf
v_sub_f32 v38, v36, v28
v_sub_f32 v39, v37, v29
v_exp_f32 v38, v38
v_exp_f32 v39, v39
v_mov_b32 v37, v62
ds_read_b128 v[32:35], v37 offset:0
ds_read_b128 v[56:59], v37 offset:1024
L_pu_21:
s_cmp_ge_u32 s55, 112
s_cbranch_scc1 L_pud_22
s_waitcnt vmcnt(6)
s_call_b64 s[60:61], L_PUMP
s_branch L_pu_21
L_pud_22:
s_waitcnt vmcnt(8)
s_barrier
v_xor_b32 v36, 0, v6
ds_read_b64_tr_b16 v[8:9], v36 offset:0
ds_read_b64_tr_b16 v[12:13], v36 offset:2048
v_xor_b32 v36, 16, v6
ds_read_b64_tr_b16 v[10:11], v36 offset:512
ds_read_b64_tr_b16 v[14:15], v36 offset:2560
v_xor_b32 v36, 64, v6
ds_read_b64_tr_b16 v[16:17], v36 offset:0
ds_read_b64_tr_b16 v[20:21], v36 offset:2048
v_xor_b32 v36, 80, v6
ds_read_b64_tr_b16 v[18:19], v36 offset:512
ds_read_b64_tr_b16 v[22:23], v36 offset:2560
v_xor_b32 v36, 32, v6
ds_read_b64_tr_b16 v[24:25], v36 offset:0
ds_read_b64_tr_b16 v[28:29], v36 offset:2048
v_xor_b32 v36, 48, v6
ds_read_b64_tr_b16 v[26:27], v36 offset:512
ds_read_b64_tr_b16 v[30:31], v36 offset:2560
s_waitcnt lgkmcnt(8)
v_smfmac_f32_16x16x64_bf16 v[40:43], v[32:35], v[8:15], v7
s_nop 1
v_xor_b32 v36, 96, v6
ds_read_b64_tr_b16 v[8:9], v36 offset:0
ds_read_b64_tr_b16 v[12:13], v36 offset:2048
v_xor_b32 v36, 112, v6
ds_read_b64_tr_b16 v[10:11], v36 offset:512
ds_read_b64_tr_b16 v[14:15], v36 offset:2560
s_waitcnt lgkmcnt(8)
v_smfmac_f32_16x16x64_bf16 v[48:51], v[32:35], v[16:23], v7
L_pu_23:
s_cmp_ge_u32 s55, 120
s_cbranch_scc1 L_pud_24
s_waitcnt vmcnt(6)
s_call_b64 s[60:61], L_PUMP
s_branch L_pu_23
L_pud_24:
s_waitcnt vmcnt(8)
s_barrier
v_xor_b32 v36, 0, v6
ds_read_b64_tr_b16 v[16:17], v36 offset:32768
ds_read_b64_tr_b16 v[20:21], v36 offset:34816
v_xor_b32 v36, 16, v6
ds_read_b64_tr_b16 v[18:19], v36 offset:33280
ds_read_b64_tr_b16 v[22:23], v36 offset:35328
s_waitcnt lgkmcnt(8)
v_smfmac_f32_16x16x64_bf16 v[44:47], v[32:35], v[24:31], v7
s_nop 1
v_xor_b32 v36, 64, v6
ds_read_b64_tr_b16 v[24:25], v36 offset:32768
ds_read_b64_tr_b16 v[28:29], v36 offset:34816
v_xor_b32 v36, 80, v6
ds_read_b64_tr_b16 v[26:27], v36 offset:33280
ds_read_b64_tr_b16 v[30:31], v36 offset:35328
s_waitcnt lgkmcnt(8)
v_smfmac_f32_16x16x64_bf16 v[52:55], v[32:35], v[8:15], v7
s_nop 1
v_xor_b32 v36, 32, v6
ds_read_b64_tr_b16 v[8:9], v36 offset:32768
ds_read_b64_tr_b16 v[12:13], v36 offset:34816
v_xor_b32 v36, 48, v6
ds_read_b64_tr_b16 v[10:11], v36 offset:33280
ds_read_b64_tr_b16 v[14:15], v36 offset:35328
ds_read_b128 v[32:35], v37 offset:2048
s_waitcnt lgkmcnt(9)
v_smfmac_f32_16x16x64_bf16 v[40:43], v[56:59], v[16:23], v7
s_nop 1
v_xor_b32 v36, 96, v6
ds_read_b64_tr_b16 v[16:17], v36 offset:32768
ds_read_b64_tr_b16 v[20:21], v36 offset:34816
v_xor_b32 v36, 112, v6
ds_read_b64_tr_b16 v[18:19], v36 offset:33280
ds_read_b64_tr_b16 v[22:23], v36 offset:35328
s_waitcnt lgkmcnt(9)
v_smfmac_f32_16x16x64_bf16 v[48:51], v[56:59], v[24:31], v7
L_pu_25:
s_cmp_ge_u32 s55, 128
s_cbranch_scc1 L_pud_26
s_waitcnt vmcnt(6)
s_call_b64 s[60:61], L_PUMP
s_branch L_pu_25
L_pud_26:
s_mov_b32 s80, s36
s_mov_b32 s81, s37
v_lshrrev_b32 v5, 6, v0
v_mul_u32_u24 v5, 896, v5
v_and_or_b32 v5, v0, 48, v5
s_lshl_b32 s77, s34, 9
s_lshl_b32 s78, s92, 8
s_add_u32 s77, s77, s78
s_lshl_b32 s78, s52, 6
s_add_u32 s77, s77, s78
s_mul_i32 s77, s77, 896
s_lshl_b32 s78, s93, 6
s_add_u32 s77, s77, s78
s_cmp_ge_u32 s35, 28
s_cselect_b32 s77, 0x40000000, s77
s_lshl_b32 s78, s52, 12
s_add_u32 s78, s78, 131072
s_mov_b32 s36, s26
s_mov_b32 s37, s27
s_mov_b32 s38, 3670016
s_add_u32 m0, s78, 0
s_add_u32 s79, s77, 0
buffer_load_dwordx4 v5, s[36:39], s79 offen nt lds
s_add_u32 m0, s78, 1024
s_add_u32 s79, s77, 14336
buffer_load_dwordx4 v5, s[36:39], s79 offen nt lds
s_add_u32 m0, s78, 2048
s_add_u32 s79, s77, 28672
buffer_load_dwordx4 v5, s[36:39], s79 offen nt lds
s_add_u32 m0, s78, 3072
s_add_u32 s79, s77, 43008
buffer_load_dwordx4 v5, s[36:39], s79 offen nt lds
s_mov_b32 s36, s80
s_mov_b32 s37, s81
s_mov_b32 s38, 0x20000
s_waitcnt vmcnt(12)
s_barrier
v_xor_b32 v36, 65536, v6
ds_read_b64_tr_b16 v[24:25], v36 offset:0
ds_read_b64_tr_b16 v[28:29], v36 offset:2048
v_xor_b32 v36, 65552, v6
ds_read_b64_tr_b16 v[26:27], v36 offset:512
ds_read_b64_tr_b16 v[30:31], v36 offset:2560
s_waitcnt lgkmcnt(9)
v_smfmac_f32_16x16x64_bf16 v[44:47], v[56:59], v[8:15], v7
s_nop 1
v_xor_b32 v36, 65600, v6
ds_read_b64_tr_b16 v[8:9], v36 offset:0
ds_read_b64_tr_b16 v[12:13], v36 offset:2048
v_xor_b32 v36, 65616, v6
ds_read_b64_tr_b16 v[10:11], v36 offset:512
ds_read_b64_tr_b16 v[14:15], v36 offset:2560
s_waitcnt lgkmcnt(8)
v_smfmac_f32_16x16x64_bf16 v[52:55], v[56:59], v[16:23], v7
s_nop 1
v_xor_b32 v36, 65568, v6
ds_read_b64_tr_b16 v[16:17], v36 offset:0
ds_read_b64_tr_b16 v[20:21], v36 offset:2048
v_xor_b32 v36, 65584, v6
ds_read_b64_tr_b16 v[18:19], v36 offset:512
ds_read_b64_tr_b16 v[22:23], v36 offset:2560
ds_read_b128 v[56:59], v37 offset:3072
s_waitcnt lgkmcnt(9)
v_smfmac_f32_16x16x64_bf16 v[40:43], v[32:35], v[24:31], v7
s_nop 1
v_xor_b32 v36, 65632, v6
ds_read_b64_tr_b16 v[24:25], v36 offset:0
ds_read_b64_tr_b16 v[28:29], v36 offset:2048
v_xor_b32 v36, 65648, v6
ds_read_b64_tr_b16 v[26:27], v36 offset:512
ds_read_b64_tr_b16 v[30:31], v36 offset:2560
s_waitcnt lgkmcnt(9)
v_smfmac_f32_16x16x64_bf16 v[48:51], v[32:35], v[8:15], v7
s_waitcnt lgkmcnt(5)
v_smfmac_f32_16x16x64_bf16 v[44:47], v[32:35], v[16:23], v7
s_waitcnt lgkmcnt(0)
v_smfmac_f32_16x16x64_bf16 v[52:55], v[32:35], v[24:31], v7
L_pu_27:
s_cmp_ge_u32 s55, 128
s_cbranch_scc1 L_pud_28
s_waitcnt vmcnt(6)
s_call_b64 s[60:61], L_PUMP
s_branch L_pu_27
L_pud_28:
s_waitcnt vmcnt(4)
s_barrier
v_xor_b32 v36, 65536, v6
ds_read_b64_tr_b16 v[8:9], v36 offset:32768
ds_read_b64_tr_b16 v[12:13], v36 offset:34816
v_xor_b32 v36, 65552, v6
ds_read_b64_tr_b16 v[10:11], v36 offset:33280
ds_read_b64_tr_b16 v[14:15], v36 offset:35328
v_xor_b32 v36, 65600, v6
ds_read_b64_tr_b16 v[16:17], v36 offset:32768
ds_read_b64_tr_b16 v[20:21], v36 offset:34816
v_xor_b32 v36, 65616, v6
ds_read_b64_tr_b16 v[18:19], v36 offset:33280
ds_read_b64_tr_b16 v[22:23], v36 offset:35328
v_xor_b32 v36, 65568, v6
ds_read_b64_tr_b16 v[24:25], v36 offset:32768
ds_read_b64_tr_b16 v[28:29], v36 offset:34816
v_xor_b32 v36, 65584, v6
ds_read_b64_tr_b16 v[26:27], v36 offset:33280
ds_read_b64_tr_b16 v[30:31], v36 offset:35328
s_waitcnt lgkmcnt(8)
v_smfmac_f32_16x16x64_bf16 v[40:43], v[56:59], v[8:15], v7
s_nop 3
v_xor_b32 v36, 65632, v6
ds_read_b64_tr_b16 v[8:9], v36 offset:32768
ds_read_b64_tr_b16 v[12:13], v36 offset:34816
v_xor_b32 v36, 65648, v6
ds_read_b64_tr_b16 v[10:11], v36 offset:33280
ds_read_b64_tr_b16 v[14:15], v36 offset:35328
s_waitcnt lgkmcnt(8)
v_smfmac_f32_16x16x64_bf16 v[48:51], v[56:59], v[16:23], v7
s_waitcnt lgkmcnt(4)
v_smfmac_f32_16x16x64_bf16 v[44:47], v[56:59], v[24:31], v7
s_waitcnt lgkmcnt(0)
v_smfmac_f32_16x16x64_bf16 v[52:55], v[56:59], v[8:15], v7
L_PEND:
v_pk_add_f32 v[40:41], v[40:41], v[42:43]
v_pk_mul_f32 v[40:41], v[40:41], v[38:39]
v_pk_add_f32 v[48:49], v[48:49], v[50:51]
s_branch L_POST
L_OWB0:
s_nop 3
v_lshrrev_b32 v55, 8, v0
v_lshlrev_b32 v55, 3, v55
v_bfe_u32 v24, v0, 6, 2
v_add_u32 v55, v55, v24
v_lshlrev_b32 v55, 6, v55
v_bfe_u32 v24, v0, 4, 2
v_lshl_add_u32 v55, v24, 3, v55
s_lshl_b32 s77, s52, 12
s_add_u32 s77, s77, 131072
v_add_u32 v55, s77, v55
ds_read_b64_tr_b16 v[24:25], v55 offset:0
ds_read_b64_tr_b16 v[26:27], v55 offset:256
ds_read_b64_tr_b16 v[28:29], v55 offset:32
ds_read_b64_tr_b16 v[30:31], v55 offset:288
ds_read_b64_tr_b16 v[32:33], v55 offset:2048
ds_read_b64_tr_b16 v[34:35], v55 offset:2304
ds_read_b64_tr_b16 v[36:37], v55 offset:2080
ds_read_b64_tr_b16 v[38:39], v55 offset:2336
s_waitcnt lgkmcnt(0)
s_branch L_OWJ0
L_OCS:
v_mfma_f32_16x16x32_bf16 v[40:43], v[8:11], v[24:27], 0
v_mfma_f32_16x16x32_bf16 v[40:43], v[12:15], v[32:35], v[40:43]
v_mfma_f32_16x16x32_bf16 v[44:47], v[8:11], v[28:31], 0
v_mfma_f32_16x16x32_bf16 v[44:47], v[12:15], v[36:39], v[44:47]
v_mfma_f32_16x16x32_bf16 v[48:51], v[16:19], v[24:27], 0
s_nop 3
s_branch L_OOK
L_OSF:
s_sub_u32 s68, s68, 1
s_cbranch_scc1 L_END
s_cmp_lt_u32 s55, 128
s_cbranch_scc1 L_OS1
buffer_load_dwordx4 v[56:59], v124, s[44:47], s72 offen sc1
buffer_load_dwordx4 v[60:63], v124, s[44:47], s72 offen offset:512 sc1
s_cmp_lg_u32 s65, 0
s_cbranch_scc1 L_OSF1
s_mov_b32 s65, 1
s_waitcnt vmcnt(2)
buffer_load_dwordx4 v[8:11], v123, s[44:47], s70 offen offset:0 sc1
buffer_load_dwordx4 v[12:15], v123, s[44:47], s70 offen offset:2048 sc1
buffer_load_dwordx4 v[16:19], v123, s[44:47], s70 offen offset:1024 sc1
buffer_load_dwordx4 v[20:23], v123, s[44:47], s70 offen offset:3072 sc1
s_bitcmp1_b32 s66, 0
s_cbranch_scc1 L_OWB1
v_mov_b32 v24, v80
v_mov_b32 v25, v81
v_mov_b32 v26, v82
v_mov_b32 v27, v83
v_mov_b32 v28, v84
v_mov_b32 v29, v85
v_mov_b32 v30, v86
v_mov_b32 v31, v87
v_mov_b32 v32, v88
v_mov_b32 v33, v89
v_mov_b32 v34, v90
v_mov_b32 v35, v91
v_mov_b32 v36, v92
v_mov_b32 v37, v93
v_mov_b32 v38, v94
v_mov_b32 v39, v95
L_OWJ1:
s_waitcnt vmcnt(4)
s_branch L_OSC
L_OSF1:
s_waitcnt vmcnt(0)
s_branch L_OSC
L_OF:
s_sub_u32 s68, s68, 1
s_cbranch_scc1 L_END
s_cmp_lt_u32 s55, 128
s_cbranch_scc1 L_OS1
s_branch L_OR
L_OSA:
s_mov_b32 s65, 1
v_max3_u32 v48, v8, v9, v10
v_max3_u32 v48, v48, v11, v12
v_max3_u32 v48, v48, v13, v14
v_max3_u32 v48, v48, v15, v16
v_max3_u32 v48, v48, v17, v18
v_max3_u32 v48, v48, v19, v20
v_max3_u32 v48, v48, v21, v22
v_max_u32 v48, v48, v23
v_cmp_eq_u32 vcc, -1, v48
s_cbranch_vccz L_OSC
s_sub_u32 s68, s68, 1
s_cbranch_scc1 L_END
s_branch L_OS1
L_OS0:
s_mov_b32 s80, s36
s_mov_b32 s81, s37
v_lshrrev_b32 v5, 6, v0
v_mul_u32_u24 v5, 896, v5
v_and_or_b32 v5, v0, 48, v5
s_lshl_b32 s77, s34, 9
s_lshl_b32 s78, s92, 8
s_add_u32 s77, s77, s78
s_lshl_b32 s78, s52, 6
s_add_u32 s77, s77, s78
s_mul_i32 s77, s77, 896
s_lshl_b32 s78, s93, 6
s_add_u32 s77, s77, s78
s_cmp_ge_u32 s35, 28
s_cselect_b32 s77, 0x40000000, s77
s_lshl_b32 s78, s52, 12
s_add_u32 s78, s78, 131072
s_mov_b32 s36, s16
s_mov_b32 s37, s17
s_mov_b32 s38, 3670016
s_add_u32 m0, s78, 0
s_add_u32 s79, s77, 0
buffer_load_dwordx4 v5, s[36:39], s79 offen nt lds
s_add_u32 m0, s78, 1024
s_add_u32 s79, s77, 14336
buffer_load_dwordx4 v5, s[36:39], s79 offen nt lds
s_add_u32 m0, s78, 2048
s_add_u32 s79, s77, 28672
buffer_load_dwordx4 v5, s[36:39], s79 offen nt lds
s_add_u32 m0, s78, 3072
s_add_u32 s79, s77, 43008
buffer_load_dwordx4 v5, s[36:39], s79 offen nt lds
s_mov_b32 s36, s80
s_mov_b32 s37, s81
s_mov_b32 s38, 0x20000
v_and_b32 v47, 0xf0, v0
v_and_b32 v46, 0x100, v0
v_lshl_add_u32 v47, v46, 2, v47
v_sub_u32 v46, v123, v0
v_add_u32 v47, v47, v46
s_mov_b32 s65, 2
L_OPR:
s_mov_b32 exec_lo, -1
s_mov_b32 exec_hi, 0
buffer_load_dword v46, v47, s[44:47], s70 offen sc1
s_mov_b64 exec, -1
s_branch L_OPRS
L_OPRC:
s_mov_b32 exec_lo, -1
s_mov_b32 exec_hi, 0
v_cmp_eq_u32 vcc, -1, v46
s_mov_b64 exec, -1
s_cbranch_vccz L_OPD
s_sub_u32 s68, s68, 1
s_cbranch_scc1 L_END
s_branch L_OPR
L_NOO0:
s_cmp_eq_u32 s66, 0
s_cbranch_scc0 L_NOO
L_pu_29:
s_cmp_ge_u32 s55, 81
s_cbranch_scc1 L_pud_30
s_waitcnt vmcnt(4)
s_call_b64 s[60:61], L_PUMP
s_branch L_pu_29
L_pud_30:
s_branch L_OS0
L_OPD:
s_cmp_ge_u32 s35, 28
s_cbranch_scc1 L_NOO
buffer_load_dwordx4 v[56:59], v124, s[44:47], s72 offen sc1
buffer_load_dwordx4 v[60:63], v124, s[44:47], s72 offen offset:512 sc1
buffer_load_dwordx4 v[8:11], v123, s[44:47], s70 offen offset:0 sc1
buffer_load_dwordx4 v[12:15], v123, s[44:47], s70 offen offset:2048 sc1
buffer_load_dwordx4 v[16:19], v123, s[44:47], s70 offen offset:1024 sc1
buffer_load_dwordx4 v[20:23], v123, s[44:47], s70 offen offset:3072 sc1
v_lshrrev_b32 v5, 8, v0
v_lshlrev_b32 v5, 3, v5
v_bfe_u32 v80, v0, 6, 2
v_add_u32 v5, v5, v80
v_lshlrev_b32 v5, 6, v5
v_bfe_u32 v80, v0, 4, 2
v_lshl_add_u32 v5, v80, 3, v5
s_lshl_b32 s77, s52, 12
s_add_u32 s77, s77, 131072
v_add_u32 v5, s77, v5
ds_read_b64_tr_b16 v[80:81], v5 offset:0
ds_read_b64_tr_b16 v[82:83], v5 offset:256
ds_read_b64_tr_b16 v[84:85], v5 offset:32
ds_read_b64_tr_b16 v[86:87], v5 offset:288
ds_read_b64_tr_b16 v[88:89], v5 offset:2048
ds_read_b64_tr_b16 v[90:91], v5 offset:2304
ds_read_b64_tr_b16 v[92:93], v5 offset:2080
ds_read_b64_tr_b16 v[94:95], v5 offset:2336
s_waitcnt lgkmcnt(0)
v_lshrrev_b32 v5, 8, v0
v_lshlrev_b32 v5, 3, v5
v_bfe_u32 v24, v0, 6, 2
v_add_u32 v5, v5, v24
v_lshlrev_b32 v5, 6, v5
v_bfe_u32 v24, v0, 4, 2
v_lshl_add_u32 v5, v24, 3, v5
s_lshl_b32 s77, s52, 12
s_add_u32 s77, s77, 131072
v_add_u32 v5, s77, v5
ds_read_b64_tr_b16 v[24:25], v5 offset:0
ds_read_b64_tr_b16 v[26:27], v5 offset:256
ds_read_b64_tr_b16 v[28:29], v5 offset:32
ds_read_b64_tr_b16 v[30:31], v5 offset:288
ds_read_b64_tr_b16 v[32:33], v5 offset:2048
ds_read_b64_tr_b16 v[34:35], v5 offset:2304
ds_read_b64_tr_b16 v[36:37], v5 offset:2080
ds_read_b64_tr_b16 v[38:39], v5 offset:2336
s_waitcnt lgkmcnt(0)
s_branch L_OS3
L_OS1:
buffer_load_dwordx4 v[56:59], v124, s[44:47], s72 offen sc1
buffer_load_dwordx4 v[60:63], v124, s[44:47], s72 offen offset:512 sc1
buffer_load_dwordx4 v[8:11], v123, s[44:47], s70 offen offset:0 sc1
buffer_load_dwordx4 v[12:15], v123, s[44:47], s70 offen offset:2048 sc1
buffer_load_dwordx4 v[16:19], v123, s[44:47], s70 offen offset:1024 sc1
buffer_load_dwordx4 v[20:23], v123, s[44:47], s70 offen offset:3072 sc1
L_OS3:
s_waitcnt vmcnt(12)
s_call_b64 s[60:61], L_PUMP
s_waitcnt vmcnt(12)
s_call_b64 s[60:61], L_PUMP
s_waitcnt vmcnt(12)
s_call_b64 s[60:61], L_PUMP
s_waitcnt vmcnt(12)
s_call_b64 s[60:61], L_PUMP
s_waitcnt vmcnt(8)
s_cmp_lt_u32 s55, s56
s_cbranch_scc1 L_dr_31
s_waitcnt vmcnt(0)
L_dr_31:
s_branch L_OSA
L_LAST:
s_cmp_ge_u32 s35, 28
s_cselect_b32 s77, 1, s52
s_or_b32 s77, s77, s34
s_cbranch_scc1 L_END
s_mov_b32 s40, s28
s_mov_b32 s41, s29
s_mov_b32 s42, 7168
s_mov_b32 s6, 0
s_mov_b32 s67, 0
s_mov_b32 s75, 0
v_bfe_u32 v113, v0, 6, 3
v_mul_u32_u24 v113, 896, v113
v_bfe_u32 v41, v0, 4, 2
v_lshl_add_u32 v113, v41, 3, v113
v_lshrrev_b32 v41, 9, v0
v_lshl_add_u32 v113, v41, 2, v113
s_lshl_b32 s77, s35, 5
v_add_u32 v113, s77, v113
s_branch L_XGO
L_PRELOADA:
s_call_b64 s[62:63], L_MOVEV0
s_call_b64 s[62:63], L_MOVEV1
s_call_b64 s[62:63], L_MOVEV2
s_call_b64 s[62:63], L_MOVEV3
s_mov_b32 s75, 0
s_branch L_PRELDA
L_PRELOADB:
s_call_b64 s[62:63], L_MOVEV0
s_call_b64 s[62:63], L_MOVEV1
s_call_b64 s[62:63], L_MOVEV2
s_call_b64 s[62:63], L_MOVEV3
s_mov_b32 s75, 0
s_branch L_PRELDB
L_XNAN:
s_add_u32 s76, s76, 1
s_and_b32 s77, s76, 3
s_cbranch_scc1 L_XPOLL
v_max3_u32 v57, v24, v25, v26
v_max3_u32 v57, v57, v27, v28
v_max3_u32 v57, v57, v29, v30
v_max3_u32 v57, v57, v31, v32
v_max3_u32 v57, v57, v33, v34
v_max3_u32 v57, v57, v35, v36
v_max3_u32 v57, v57, v37, v38
v_max3_u32 v57, v57, v39, v40
v_max3_u32 v57, v57, v41, v42
v_max3_u32 v57, v57, v43, v44
v_max3_u32 v57, v57, v45, v46
v_max3_u32 v57, v57, v47, v48
v_max3_u32 v57, v57, v49, v50
v_max3_u32 v57, v57, v51, v52
v_max3_u32 v57, v57, v53, v54
v_max_u32 v57, v57, v55
v_cmp_eq_u32 vcc, -1, v57
s_cbranch_vccz L_XOK
s_sub_u32 s68, s68, 1
s_cbranch_scc1 L_END
s_branch L_XPOLL
L_X0:
s_cmp_ge_u32 s35, 28
s_cbranch_scc0 L_X0W
s_waitcnt vmcnt(4)
s_call_b64 s[60:61], L_PUMP
s_waitcnt vmcnt(4)
s_call_b64 s[60:61], L_PUMP
s_waitcnt vmcnt(4)
s_call_b64 s[60:61], L_PUMP
s_waitcnt vmcnt(6)
s_cmp_lt_u32 s55, s56
s_cbranch_scc1 L_dr_32
s_waitcnt vmcnt(0)
L_dr_32:
s_sub_u32 s77, s35, 28
s_lshl_b32 s77, s77, 2
s_add_u32 s77, s77, s52
v_lshrrev_b32 v60, 9, v0
v_lshl_add_u32 v60, v60, 4, s77
v_and_b32 v61, 0x1f0, v0
v_lshl_add_u32 v61, v60, 13, v61
v_bfe_u32 v62, v0, 6, 3
v_mul_u32_u24 v62, 896, v62
v_bfe_u32 v63, v0, 4, 2
v_lshl_add_u32 v62, v63, 3, v62
v_lshl_add_u32 v62, v60, 5, v62
v_bfe_u32 v1, v0, 5, 1
v_lshlrev_b32 v1, 7, v1
v_bfe_u32 v63, v0, 6, 3
v_lshl_add_u32 v1, v63, 4, v1
v_bfe_u32 v63, v0, 4, 1
v_lshl_add_u32 v1, v63, 3, v1
v_lshl_add_u32 v1, v60, 8, v1
v_cmp_le_u32 vcc, 28, v60
v_mov_b32 v60, 0x40000000
s_nop 0
v_cndmask_b32 v61, v61, v60, vcc
v_cndmask_b32 v1, v1, v60, vcc
buffer_load_dwordx2 v[62:63], v62, s[48:51], 0 offen
s_add_u32 s82, s73, 4096
L_CXP:
buffer_load_dwordx4 v[8:11], v61, s[44:47], s73 offen offset:0 sc1
buffer_load_dwordx4 v[12:15], v61, s[44:47], s73 offen offset:512 sc1
buffer_load_dwordx4 v[16:19], v61, s[44:47], s73 offen offset:1024 sc1
buffer_load_dwordx4 v[20:23], v61, s[44:47], s73 offen offset:1536 sc1
buffer_load_dwordx4 v[24:27], v61, s[44:47], s73 offen offset:2048 sc1
buffer_load_dwordx4 v[28:31], v61, s[44:47], s73 offen offset:2560 sc1
buffer_load_dwordx4 v[32:35], v61, s[44:47], s73 offen offset:3072 sc1
buffer_load_dwordx4 v[36:39], v61, s[44:47], s73 offen offset:3584 sc1
buffer_load_dwordx4 v[40:43], v61, s[44:47], s82 offen offset:0 sc1
buffer_load_dwordx4 v[44:47], v61, s[44:47], s82 offen offset:512 sc1
buffer_load_dwordx4 v[48:51], v61, s[44:47], s82 offen offset:1024 sc1
buffer_load_dwordx4 v[52:55], v61, s[44:47], s82 offen offset:1536 sc1
buffer_load_dwordx4 v[80:83], v61, s[44:47], s82 offen offset:2048 sc1
buffer_load_dwordx4 v[84:87], v61, s[44:47], s82 offen offset:2560 sc1
buffer_load_dwordx4 v[88:91], v61, s[44:47], s82 offen offset:3072 sc1
buffer_load_dwordx4 v[92:95], v61, s[44:47], s82 offen offset:3584 sc1
s_waitcnt vmcnt(12)
v_max3_u32 v60, v8, v9, v10
v_max3_u32 v60, v10, v11, v60
v_mov_b32 v56, v8
v_mov_b32 v57, v9
v_mov_b32 v58, v10
v_mov_b32 v59, v11
v_max3_u32 v60, v12, v13, v60
v_max3_u32 v60, v14, v15, v60
v_pk_add_f32 v[56:57], v[56:57], v[12:13]
v_pk_add_f32 v[58:59], v[58:59], v[14:15]
v_max3_u32 v60, v16, v17, v60
v_max3_u32 v60, v18, v19, v60
v_pk_add_f32 v[56:57], v[56:57], v[16:17]
v_pk_add_f32 v[58:59], v[58:59], v[18:19]
v_max3_u32 v60, v20, v21, v60
v_max3_u32 v60, v22, v23, v60
v_pk_add_f32 v[56:57], v[56:57], v[20:21]
v_pk_add_f32 v[58:59], v[58:59], v[22:23]
s_waitcnt vmcnt(8)
v_max3_u32 v60, v24, v25, v60
v_max3_u32 v60, v26, v27, v60
v_pk_add_f32 v[56:57], v[56:57], v[24:25]
v_pk_add_f32 v[58:59], v[58:59], v[26:27]
v_max3_u32 v60, v28, v29, v60
v_max3_u32 v60, v30, v31, v60
v_pk_add_f32 v[56:57], v[56:57], v[28:29]
v_pk_add_f32 v[58:59], v[58:59], v[30:31]
v_max3_u32 v60, v32, v33, v60
v_max3_u32 v60, v34, v35, v60
v_pk_add_f32 v[56:57], v[56:57], v[32:33]
v_pk_add_f32 v[58:59], v[58:59], v[34:35]
v_max3_u32 v60, v36, v37, v60
v_max3_u32 v60, v38, v39, v60
v_pk_add_f32 v[56:57], v[56:57], v[36:37]
v_pk_add_f32 v[58:59], v[58:59], v[38:39]
s_waitcnt vmcnt(4)
v_max3_u32 v60, v40, v41, v60
v_max3_u32 v60, v42, v43, v60
v_pk_add_f32 v[56:57], v[56:57], v[40:41]
v_pk_add_f32 v[58:59], v[58:59], v[42:43]
v_max3_u32 v60, v44, v45, v60
v_max3_u32 v60, v46, v47, v60
v_pk_add_f32 v[56:57], v[56:57], v[44:45]
v_pk_add_f32 v[58:59], v[58:59], v[46:47]
v_max3_u32 v60, v48, v49, v60
v_max3_u32 v60, v50, v51, v60
v_pk_add_f32 v[56:57], v[56:57], v[48:49]
v_pk_add_f32 v[58:59], v[58:59], v[50:51]
v_max3_u32 v60, v52, v53, v60
v_max3_u32 v60, v54, v55, v60
v_pk_add_f32 v[56:57], v[56:57], v[52:53]
v_pk_add_f32 v[58:59], v[58:59], v[54:55]
s_waitcnt vmcnt(0)
v_max3_u32 v60, v80, v81, v60
v_max3_u32 v60, v82, v83, v60
v_pk_add_f32 v[56:57], v[56:57], v[80:81]
v_pk_add_f32 v[58:59], v[58:59], v[82:83]
v_max3_u32 v60, v84, v85, v60
v_max3_u32 v60, v86, v87, v60
v_pk_add_f32 v[56:57], v[56:57], v[84:85]
v_pk_add_f32 v[58:59], v[58:59], v[86:87]
v_max3_u32 v60, v88, v89, v60
v_max3_u32 v60, v90, v91, v60
v_pk_add_f32 v[56:57], v[56:57], v[88:89]
v_pk_add_f32 v[58:59], v[58:59], v[90:91]
v_max3_u32 v60, v92, v93, v60
v_max3_u32 v60, v94, v95, v60
v_pk_add_f32 v[56:57], v[56:57], v[92:93]
v_pk_add_f32 v[58:59], v[58:59], v[94:95]
v_cmp_eq_u32 vcc, -1, v60
s_cbranch_vccz L_CXD
s_sub_u32 s68, s68, 1
s_cbranch_scc1 L_END
s_branch L_CXP
L_CXD:
v_cvt_pk_bf16_f32 v56, v56, v57
v_cvt_pk_bf16_f32 v57, v58, v59
v_lshlrev_b32 v8, 16, v56
v_and_b32 v9, 0xffff0000, v56
v_lshlrev_b32 v10, 16, v57
v_and_b32 v11, 0xffff0000, v57
v_lshlrev_b32 v12, 16, v62
v_and_b32 v13, 0xffff0000, v62
v_lshlrev_b32 v14, 16, v63
v_and_b32 v15, 0xffff0000, v63
v_pk_add_f32 v[8:9], v[8:9], v[12:13]
v_pk_add_f32 v[10:11], v[10:11], v[14:15]
v_cvt_pk_bf16_f32 v56, v8, v9
v_cvt_pk_bf16_f32 v57, v10, v11
v_min_u32 v56, -2, v56
v_min_u32 v57, -2, v57
buffer_store_dwordx2 v[56:57], v1, s[40:43], s74 offen
buffer_store_dwordx2 v[56:57], v1, s[4:7], s74 offen sc1
s_branch L_NODR2
L_X0W:
s_mov_b32 s80, s36
s_mov_b32 s81, s37
v_lshrrev_b32 v5, 5, v0
v_lshlrev_b32 v5, 13, v5
v_and_or_b32 v5, v0, 16, v5
s_lshl_b32 s77, s52, 20
s_lshl_b32 s78, s34, 10
s_add_u32 s77, s77, s78
s_lshl_b32 s78, s35, 5
s_add_u32 s77, s77, s78
s_lshl_b32 s78, s52, 12
s_add_u32 s78, s78, 131072
s_mov_b32 s36, s24
s_mov_b32 s37, s25
s_mov_b32 s38, 3670016
s_add_u32 m0, s78, 0
s_add_u32 s79, s77, 0
buffer_load_dwordx4 v5, s[36:39], s79 offen nt lds
s_add_u32 m0, s78, 1024
s_add_u32 s79, s77, 262144
buffer_load_dwordx4 v5, s[36:39], s79 offen nt lds
s_add_u32 m0, s78, 2048
s_add_u32 s79, s77, 524288
buffer_load_dwordx4 v5, s[36:39], s79 offen nt lds
s_add_u32 m0, s78, 3072
s_add_u32 s79, s77, 786432
buffer_load_dwordx4 v5, s[36:39], s79 offen nt lds
s_mov_b32 s36, s80
s_mov_b32 s37, s81
s_mov_b32 s38, 0x20000
s_waitcnt vmcnt(16)
s_call_b64 s[60:61], L_PUMP
s_waitcnt vmcnt(16)
s_call_b64 s[60:61], L_PUMP
s_waitcnt vmcnt(16)
s_call_b64 s[60:61], L_PUMP
s_waitcnt vmcnt(16)
s_call_b64 s[60:61], L_PUMP
s_waitcnt vmcnt(16)
s_call_b64 s[60:61], L_PUMP
s_waitcnt vmcnt(16)
s_call_b64 s[60:61], L_PUMP
s_waitcnt vmcnt(16)
s_call_b64 s[60:61], L_PUMP
s_waitcnt vmcnt(14)
s_cmp_lt_u32 s55, s56
s_cbranch_scc1 L_dr_33
s_waitcnt vmcnt(0)
L_dr_33:
v_lshrrev_b32 v5, 8, v0
v_lshlrev_b32 v5, 8, v5
v_bfe_u32 v96, v0, 4, 4
v_lshl_add_u32 v5, v96, 3, v5
s_lshl_b32 s77, s52, 12
s_add_u32 s77, s77, 131072
v_add_u32 v5, s77, v5
ds_read_b64_tr_b16 v[96:97], v5 offset:0
ds_read_b64_tr_b16 v[98:99], v5 offset:128
ds_read_b64_tr_b16 v[100:101], v5 offset:1024
ds_read_b64_tr_b16 v[102:103], v5 offset:1152
ds_read_b64_tr_b16 v[104:105], v5 offset:2048
ds_read_b64_tr_b16 v[106:107], v5 offset:2176
ds_read_b64_tr_b16 v[108:109], v5 offset:3072
ds_read_b64_tr_b16 v[110:111], v5 offset:3200
s_waitcnt lgkmcnt(0)
s_barrier
s_branch L_NODR2
L_QBF:
s_sub_u32 s68, s68, 1
s_cbranch_scc1 L_END
s_cmp_lt_u32 s66, 2
s_cbranch_scc0 L_QBR
s_branch L_QBS1
L_QBS0:
s_mov_b32 s65, 2
s_not_b64 exec, s[86:87]
v_mov_b32 v8, 0x3f803f80
v_mov_b32 v9, 0x3f803f80
v_mov_b32 v10, 0x3f803f80
v_mov_b32 v11, 0x3f803f80
v_mov_b32 v12, 0x3f803f80
v_mov_b32 v13, 0x3f803f80
v_mov_b32 v14, 0x3f803f80
v_mov_b32 v15, 0x3f803f80
v_mov_b32 v16, 0x3f803f80
v_mov_b32 v17, 0x3f803f80
v_mov_b32 v18, 0x3f803f80
v_mov_b32 v19, 0x3f803f80
v_mov_b32 v20, 0x3f803f80
v_mov_b32 v21, 0x3f803f80
v_mov_b32 v22, 0x3f803f80
v_mov_b32 v23, 0x3f803f80
s_mov_b64 exec, -1
L_QBS1:
s_mov_b64 exec, s[86:87]
buffer_load_dwordx4 v[8:11], v112, s[48:51], 0 offen offset:0 sc1
buffer_load_dwordx4 v[12:15], v112, s[48:51], 0 offen offset:512 sc1
buffer_load_dwordx4 v[16:19], v112, s[48:51], 0 offen offset:1024 sc1
buffer_load_dwordx4 v[20:23], v112, s[48:51], 0 offen offset:1536 sc1
s_mov_b64 exec, -1
L_QBS:
s_waitcnt vmcnt(16)
s_call_b64 s[60:61], L_PUMP
s_waitcnt vmcnt(14)
s_cmp_lt_u32 s55, s56
s_cbranch_scc1 L_QBS_w
s_waitcnt vmcnt(0)
s_branch L_QBC
L_QBS_w:
s_sub_u32 s65, s65, 1
s_cbranch_scc0 L_QBS1
s_mov_b32 s65, 0
s_branch L_QBC
L_ABF:
s_nop 7
v_mov_b32 v24, 0
v_mov_b32 v25, 0
v_mov_b32 v26, 0
v_mov_b32 v27, 0
s_sub_u32 s68, s68, 1
s_cbranch_scc1 L_END
s_branch L_ABR
L_ABS0:
s_mov_b32 s65, 2
v_mov_b32 v24, 0
v_mov_b32 v25, 0
v_mov_b32 v26, 0
v_mov_b32 v27, 0
v_mov_b32 v28, 0
v_mov_b32 v29, 0
v_mov_b32 v30, 0
v_mov_b32 v31, 0
v_mov_b32 v32, 0
v_mov_b32 v33, 0
v_mov_b32 v34, 0
v_mov_b32 v35, 0
v_mov_b32 v36, 0
v_mov_b32 v37, 0
v_mov_b32 v38, 0
v_mov_b32 v39, 0
v_mov_b32 v40, 0
v_mov_b32 v41, 0
v_mov_b32 v42, 0
v_mov_b32 v43, 0
v_mov_b32 v44, 0
v_mov_b32 v45, 0
v_mov_b32 v46, 0
v_mov_b32 v47, 0
v_mov_b32 v48, 0
v_mov_b32 v49, 0
v_mov_b32 v50, 0
v_mov_b32 v51, 0
v_mov_b32 v52, 0
v_mov_b32 v53, 0
v_mov_b32 v54, 0
v_mov_b32 v55, 0
s_branch L_ABS1
L_ABLC:
v_and_b32 v59, 0x3ff, v120
v_add_u32 v59, 160768, v59
ds_read_b128 v[8:11], v59 offset:0
ds_read_b128 v[12:15], v59 offset:256
ds_read_b128 v[16:19], v59 offset:512
ds_read_b128 v[20:23], v59 offset:768
s_waitcnt lgkmcnt(0)
v_max3_u32 v58, v8, v9, v10
v_max3_u32 v58, v58, v11, v12
v_max3_u32 v58, v58, v13, v14
v_max3_u32 v58, v58, v15, v16
v_max3_u32 v58, v58, v17, v18
v_max3_u32 v58, v58, v19, v20
v_max3_u32 v58, v58, v21, v22
v_max_u32 v58, v58, v23
v_cmp_eq_u32 vcc, -1, v58
s_cbranch_vccnz L_ABLF
v_smfmac_f32_16x16x64_bf16 v[24:27], v[8:11], a[128:135], v7
s_branch L_ABOK
L_ABLF:
s_sub_u32 s68, s68, 1
s_cbranch_scc1 L_END
L_ABS1:
s_mov_b32 m0, 160768
s_nop 0
buffer_load_dwordx4 v60, s[44:47], s69 offen sc1 lds
L_ABS:
s_waitcnt vmcnt(7)
s_call_b64 s[60:61], L_PUMP
s_waitcnt vmcnt(8)
s_cmp_lt_u32 s55, s56
s_cbranch_scc1 L_ABS_w
s_waitcnt vmcnt(0)
s_branch L_ABLC
L_ABS_w:
s_sub_u32 s65, s65, 1
s_cbranch_scc0 L_ABS1
s_mov_b32 s65, 0
s_branch L_ABLC
L_OWB1:
v_lshrrev_b32 v55, 8, v0
v_lshlrev_b32 v55, 3, v55
v_bfe_u32 v24, v0, 6, 2
v_add_u32 v55, v55, v24
v_lshlrev_b32 v55, 6, v55
v_bfe_u32 v24, v0, 4, 2
v_lshl_add_u32 v55, v24, 3, v55
s_lshl_b32 s77, s52, 12
s_add_u32 s77, s77, 131072
v_add_u32 v55, s77, v55
ds_read_b64_tr_b16 v[24:25], v55 offset:0
ds_read_b64_tr_b16 v[26:27], v55 offset:256
ds_read_b64_tr_b16 v[28:29], v55 offset:32
ds_read_b64_tr_b16 v[30:31], v55 offset:288
ds_read_b64_tr_b16 v[32:33], v55 offset:2048
ds_read_b64_tr_b16 v[34:35], v55 offset:2304
ds_read_b64_tr_b16 v[36:37], v55 offset:2080
ds_read_b64_tr_b16 v[38:39], v55 offset:2336
s_waitcnt lgkmcnt(0)
s_branch L_OWJ1
L_OPRS:
s_waitcnt vmcnt(6)
s_call_b64 s[60:61], L_PUMP
s_waitcnt vmcnt(8)
s_cmp_lt_u32 s55, s56
s_cbranch_scc1 L_OPRS_w
s_waitcnt vmcnt(0)
s_branch L_OPRC
L_OPRS_w:
s_sub_u32 s65, s65, 1
s_cbranch_scc0 L_OPR
s_mov_b32 s65, 0
s_branch L_OPRC
L_MOVEV0:
v_xor_b32 v5, 0, v6
ds_read_b64_tr_b16 v[128:129], v5 offset:0
ds_read_b64_tr_b16 v[132:133], v5 offset:2048
v_xor_b32 v5, 16, v6
ds_read_b64_tr_b16 v[130:131], v5 offset:512
ds_read_b64_tr_b16 v[134:135], v5 offset:2560
v_xor_b32 v5, 32, v6
ds_read_b64_tr_b16 v[136:137], v5 offset:0
ds_read_b64_tr_b16 v[140:141], v5 offset:2048
v_xor_b32 v5, 48, v6
ds_read_b64_tr_b16 v[138:139], v5 offset:512
ds_read_b64_tr_b16 v[142:143], v5 offset:2560
v_xor_b32 v5, 64, v6
ds_read_b64_tr_b16 v[144:145], v5 offset:0
ds_read_b64_tr_b16 v[148:149], v5 offset:2048
v_xor_b32 v5, 80, v6
ds_read_b64_tr_b16 v[146:147], v5 offset:512
ds_read_b64_tr_b16 v[150:151], v5 offset:2560
v_xor_b32 v5, 96, v6
ds_read_b64_tr_b16 v[152:153], v5 offset:0
ds_read_b64_tr_b16 v[156:157], v5 offset:2048
v_xor_b32 v5, 112, v6
ds_read_b64_tr_b16 v[154:155], v5 offset:512
ds_read_b64_tr_b16 v[158:159], v5 offset:2560
s_setpc_b64 s[62:63]
L_MOVEV1:
v_xor_b32 v5, 0, v6
ds_read_b64_tr_b16 v[160:161], v5 offset:32768
ds_read_b64_tr_b16 v[164:165], v5 offset:34816
v_xor_b32 v5, 16, v6
ds_read_b64_tr_b16 v[162:163], v5 offset:33280
ds_read_b64_tr_b16 v[166:167], v5 offset:35328
v_xor_b32 v5, 32, v6
ds_read_b64_tr_b16 v[168:169], v5 offset:32768
ds_read_b64_tr_b16 v[172:173], v5 offset:34816
v_xor_b32 v5, 48, v6
ds_read_b64_tr_b16 v[170:171], v5 offset:33280
ds_read_b64_tr_b16 v[174:175], v5 offset:35328
v_xor_b32 v5, 64, v6
ds_read_b64_tr_b16 v[176:177], v5 offset:32768
ds_read_b64_tr_b16 v[180:181], v5 offset:34816
v_xor_b32 v5, 80, v6
ds_read_b64_tr_b16 v[178:179], v5 offset:33280
ds_read_b64_tr_b16 v[182:183], v5 offset:35328
v_xor_b32 v5, 96, v6
ds_read_b64_tr_b16 v[184:185], v5 offset:32768
ds_read_b64_tr_b16 v[188:189], v5 offset:34816
v_xor_b32 v5, 112, v6
ds_read_b64_tr_b16 v[186:187], v5 offset:33280
ds_read_b64_tr_b16 v[190:191], v5 offset:35328
s_setpc_b64 s[62:63]
L_MOVEV2:
v_xor_b32 v5, 65536, v6
ds_read_b64_tr_b16 v[192:193], v5 offset:0
ds_read_b64_tr_b16 v[196:197], v5 offset:2048
v_xor_b32 v5, 65552, v6
ds_read_b64_tr_b16 v[194:195], v5 offset:512
ds_read_b64_tr_b16 v[198:199], v5 offset:2560
v_xor_b32 v5, 65568, v6
ds_read_b64_tr_b16 v[200:201], v5 offset:0
ds_read_b64_tr_b16 v[204:205], v5 offset:2048
v_xor_b32 v5, 65584, v6
ds_read_b64_tr_b16 v[202:203], v5 offset:512
ds_read_b64_tr_b16 v[206:207], v5 offset:2560
v_xor_b32 v5, 65600, v6
ds_read_b64_tr_b16 v[208:209], v5 offset:0
ds_read_b64_tr_b16 v[212:213], v5 offset:2048
v_xor_b32 v5, 65616, v6
ds_read_b64_tr_b16 v[210:211], v5 offset:512
ds_read_b64_tr_b16 v[214:215], v5 offset:2560
v_xor_b32 v5, 65632, v6
ds_read_b64_tr_b16 v[216:217], v5 offset:0
ds_read_b64_tr_b16 v[220:221], v5 offset:2048
v_xor_b32 v5, 65648, v6
ds_read_b64_tr_b16 v[218:219], v5 offset:512
ds_read_b64_tr_b16 v[222:223], v5 offset:2560
s_setpc_b64 s[62:63]
L_MOVEV3:
v_xor_b32 v5, 65536, v6
ds_read_b64_tr_b16 v[224:225], v5 offset:32768
ds_read_b64_tr_b16 v[228:229], v5 offset:34816
v_xor_b32 v5, 65552, v6
ds_read_b64_tr_b16 v[226:227], v5 offset:33280
ds_read_b64_tr_b16 v[230:231], v5 offset:35328
v_xor_b32 v5, 65568, v6
ds_read_b64_tr_b16 v[232:233], v5 offset:32768
ds_read_b64_tr_b16 v[236:237], v5 offset:34816
v_xor_b32 v5, 65584, v6
ds_read_b64_tr_b16 v[234:235], v5 offset:33280
ds_read_b64_tr_b16 v[238:239], v5 offset:35328
v_xor_b32 v5, 65600, v6
ds_read_b64_tr_b16 v[240:241], v5 offset:32768
ds_read_b64_tr_b16 v[244:245], v5 offset:34816
v_xor_b32 v5, 65616, v6
ds_read_b64_tr_b16 v[242:243], v5 offset:33280
ds_read_b64_tr_b16 v[246:247], v5 offset:35328
v_xor_b32 v5, 65632, v6
ds_read_b64_tr_b16 v[248:249], v5 offset:32768
ds_read_b64_tr_b16 v[252:253], v5 offset:34816
v_xor_b32 v5, 65648, v6
ds_read_b64_tr_b16 v[250:251], v5 offset:33280
ds_read_b64_tr_b16 v[254:255], v5 offset:35328
s_setpc_b64 s[62:63]
L_PSPEC:
s_cmp_ge_u32 s55, s56
s_cbranch_scc1 L_PRET
s_cmp_ge_u32 s55, 70
s_cbranch_scc1 L_PSPEC2
s_cmp_eq_u32 s55, 14
s_cbranch_scc1 L_SP14
s_cmp_eq_u32 s55, 22
s_cbranch_scc1 L_SP22
s_cmp_eq_u32 s55, 30
s_cbranch_scc1 L_SP30
s_cmp_eq_u32 s55, 32
s_cbranch_scc1 L_SP32
s_cmp_eq_u32 s55, 38
s_cbranch_scc1 L_SP38
s_cmp_eq_u32 s55, 64
s_cbranch_scc1 L_SP64
s_cmp_eq_u32 s55, 66
s_cbranch_scc1 L_SP66
s_cmp_eq_u32 s55, 68
s_cbranch_scc1 L_SP68
L_PSPEC2:
s_cmp_eq_u32 s55, 70
s_cbranch_scc1 L_SP70
s_cmp_eq_u32 s55, 72
s_cbranch_scc1 L_SP72
s_cmp_eq_u32 s55, 78
s_cbranch_scc1 L_SP78
s_cmp_eq_u32 s55, 80
s_cbranch_scc1 L_SP80
s_cmp_eq_u32 s55, 86
s_cbranch_scc1 L_SP86
s_cmp_eq_u32 s55, 94
s_cbranch_scc1 L_SP94
s_cmp_eq_u32 s55, 96
s_cbranch_scc1 L_SP96
L_SP102:
s_waitcnt vmcnt(6)
v_xor_b32 v5, 65536, v4
ds_read_b128 a[224:227], v5 offset:32768
ds_read_b128 a[240:243], v5 offset:33024
v_xor_b32 v5, 65600, v4
ds_read_b128 a[228:231], v5 offset:32768
ds_read_b128 a[244:247], v5 offset:33024
v_xor_b32 v5, 65664, v4
ds_read_b128 a[232:235], v5 offset:32768
ds_read_b128 a[248:251], v5 offset:33024
v_xor_b32 v5, 65728, v4
ds_read_b128 a[236:239], v5 offset:32768
ds_read_b128 a[252:255], v5 offset:33024
s_waitcnt lgkmcnt(0)
s_mov_b32 s59, 999
s_min_u32 s57, s59, s56
s_branch L_PGEN
L_SP14:
s_waitcnt vmcnt(6)
v_xor_b32 v5, 0, v4
ds_read_b128 a[0:3], v5 offset:0
ds_read_b128 a[16:19], v5 offset:256
v_xor_b32 v5, 64, v4
ds_read_b128 a[4:7], v5 offset:0
ds_read_b128 a[20:23], v5 offset:256
v_xor_b32 v5, 128, v4
ds_read_b128 a[8:11], v5 offset:0
ds_read_b128 a[24:27], v5 offset:256
v_xor_b32 v5, 192, v4
ds_read_b128 a[12:15], v5 offset:0
ds_read_b128 a[28:31], v5 offset:256
s_waitcnt lgkmcnt(0)
s_mov_b32 s59, 22
s_min_u32 s57, s59, s56
s_branch L_PGEN
L_SP22:
s_waitcnt vmcnt(6)
v_xor_b32 v5, 0, v4
ds_read_b128 a[32:35], v5 offset:32768
ds_read_b128 a[48:51], v5 offset:33024
v_xor_b32 v5, 64, v4
ds_read_b128 a[36:39], v5 offset:32768
ds_read_b128 a[52:55], v5 offset:33024
v_xor_b32 v5, 128, v4
ds_read_b128 a[40:43], v5 offset:32768
ds_read_b128 a[56:59], v5 offset:33024
v_xor_b32 v5, 192, v4
ds_read_b128 a[44:47], v5 offset:32768
ds_read_b128 a[60:63], v5 offset:33024
s_waitcnt lgkmcnt(0)
s_mov_b32 s59, 30
s_min_u32 s57, s59, s56
s_branch L_PGEN
L_SP30:
s_waitcnt vmcnt(6)
v_xor_b32 v5, 65536, v4
ds_read_b128 a[64:67], v5 offset:0
ds_read_b128 a[80:83], v5 offset:256
v_xor_b32 v5, 65600, v4
ds_read_b128 a[68:71], v5 offset:0
ds_read_b128 a[84:87], v5 offset:256
v_xor_b32 v5, 65664, v4
ds_read_b128 a[72:75], v5 offset:0
ds_read_b128 a[88:91], v5 offset:256
v_xor_b32 v5, 65728, v4
ds_read_b128 a[76:79], v5 offset:0
ds_read_b128 a[92:95], v5 offset:256
s_waitcnt lgkmcnt(0)
s_mov_b32 s59, 32
s_min_u32 s57, s59, s56
s_branch L_PGEN
L_SP32:
s_add_u32 s36, s12, s53
s_addc_u32 s37, s13, 0
s_mov_b32 s38, 0x20000
s_lshl_b32 s54, s52, 10
v_lshrrev_b32 v5, 5, v0
v_and_b32 v5, 16, v5
v_xor_b32 v3, v5, v0
s_mov_b32 s59, 38
s_min_u32 s57, s59, s56
s_branch L_PGEN
L_SP38:
s_waitcnt vmcnt(6)
v_xor_b32 v5, 65536, v4
ds_read_b128 a[96:99], v5 offset:32768
ds_read_b128 a[112:115], v5 offset:33024
v_xor_b32 v5, 65600, v4
ds_read_b128 a[100:103], v5 offset:32768
ds_read_b128 a[116:119], v5 offset:33024
v_xor_b32 v5, 65664, v4
ds_read_b128 a[104:107], v5 offset:32768
ds_read_b128 a[120:123], v5 offset:33024
v_xor_b32 v5, 65728, v4
ds_read_b128 a[108:111], v5 offset:32768
ds_read_b128 a[124:127], v5 offset:33024
s_waitcnt lgkmcnt(0)
s_mov_b32 s59, 64
s_min_u32 s57, s59, s56
s_branch L_PGEN
L_SP64:
s_add_u32 s36, s20, s53
s_addc_u32 s37, s21, 0
s_mov_b32 s38, 0x20000
s_lshl_b32 s54, s52, 10
v_lshrrev_b32 v5, 5, v0
v_and_b32 v5, 16, v5
v_xor_b32 v3, v5, v0
s_mov_b32 s59, 66
s_min_u32 s57, s59, s56
s_branch L_PGEN
L_SP66:
s_cmp_ge_u32 s35, 28
s_cbranch_scc0 L_on_34
s_mov_b32 s80, s36
s_mov_b32 s81, s37
v_lshrrev_b32 v5, 5, v0
v_lshlrev_b32 v5, 13, v5
v_and_or_b32 v5, v0, 16, v5
s_lshl_b32 s77, s52, 20
s_lshl_b32 s78, s34, 10
s_add_u32 s77, s77, s78
s_lshl_b32 s78, s35, 5
s_add_u32 s77, s77, s78
s_lshl_b32 s78, s52, 12
s_add_u32 s78, s78, 131072
s_mov_b32 s36, s24
s_mov_b32 s37, s25
s_mov_b32 s38, 3670016
s_add_u32 m0, s78, 0
s_add_u32 s79, s77, 0
buffer_load_dwordx4 v5, s[36:39], s79 offen nt lds
s_mov_b32 s36, s80
s_mov_b32 s37, s81
s_mov_b32 s38, 0x20000
L_on_34:
s_mov_b32 s59, 68
s_min_u32 s57, s59, s56
s_branch L_PGEN
L_SP68:
s_cmp_ge_u32 s35, 28
s_cbranch_scc0 L_on_35
s_mov_b32 s80, s36
s_mov_b32 s81, s37
v_lshrrev_b32 v5, 5, v0
v_lshlrev_b32 v5, 13, v5
v_and_or_b32 v5, v0, 16, v5
s_lshl_b32 s77, s52, 20
s_lshl_b32 s78, s34, 10
s_add_u32 s77, s77, s78
s_lshl_b32 s78, s35, 5
s_add_u32 s77, s77, s78
s_lshl_b32 s78, s52, 12
s_add_u32 s78, s78, 131072
s_mov_b32 s36, s24
s_mov_b32 s37, s25
s_mov_b32 s38, 3670016
s_add_u32 m0, s78, 1024
s_add_u32 s79, s77, 262144
buffer_load_dwordx4 v5, s[36:39], s79 offen nt lds
s_mov_b32 s36, s80
s_mov_b32 s37, s81
s_mov_b32 s38, 0x20000
L_on_35:
s_mov_b32 s59, 70
s_min_u32 s57, s59, s56
s_branch L_PGEN
L_SP70:
s_cmp_ge_u32 s35, 28
s_cbranch_scc0 L_on_36
s_mov_b32 s80, s36
s_mov_b32 s81, s37
v_lshrrev_b32 v5, 5, v0
v_lshlrev_b32 v5, 13, v5
v_and_or_b32 v5, v0, 16, v5
s_lshl_b32 s77, s52, 20
s_lshl_b32 s78, s34, 10
s_add_u32 s77, s77, s78
s_lshl_b32 s78, s35, 5
s_add_u32 s77, s77, s78
s_lshl_b32 s78, s52, 12
s_add_u32 s78, s78, 131072
s_mov_b32 s36, s24
s_mov_b32 s37, s25
s_mov_b32 s38, 3670016
s_add_u32 m0, s78, 2048
s_add_u32 s79, s77, 524288
buffer_load_dwordx4 v5, s[36:39], s79 offen nt lds
s_mov_b32 s36, s80
s_mov_b32 s37, s81
s_mov_b32 s38, 0x20000
L_on_36:
s_mov_b32 s59, 72
s_min_u32 s57, s59, s56
s_branch L_PGEN
L_SP72:
s_cmp_ge_u32 s35, 28
s_cbranch_scc0 L_on_37
s_mov_b32 s80, s36
s_mov_b32 s81, s37
v_lshrrev_b32 v5, 5, v0
v_lshlrev_b32 v5, 13, v5
v_and_or_b32 v5, v0, 16, v5
s_lshl_b32 s77, s52, 20
s_lshl_b32 s78, s34, 10
s_add_u32 s77, s77, s78
s_lshl_b32 s78, s35, 5
s_add_u32 s77, s77, s78
s_lshl_b32 s78, s52, 12
s_add_u32 s78, s78, 131072
s_mov_b32 s36, s24
s_mov_b32 s37, s25
s_mov_b32 s38, 3670016
s_add_u32 m0, s78, 3072
s_add_u32 s79, s77, 786432
buffer_load_dwordx4 v5, s[36:39], s79 offen nt lds
s_mov_b32 s36, s80
s_mov_b32 s37, s81
s_mov_b32 s38, 0x20000
L_on_37:
s_mov_b32 s59, 78
s_min_u32 s57, s59, s56
s_branch L_PGEN
L_SP78:
s_waitcnt vmcnt(6)
v_xor_b32 v5, 0, v4
ds_read_b128 a[128:131], v5 offset:0
ds_read_b128 a[144:147], v5 offset:256
v_xor_b32 v5, 64, v4
ds_read_b128 a[132:135], v5 offset:0
ds_read_b128 a[148:151], v5 offset:256
v_xor_b32 v5, 128, v4
ds_read_b128 a[136:139], v5 offset:0
ds_read_b128 a[152:155], v5 offset:256
v_xor_b32 v5, 192, v4
ds_read_b128 a[140:143], v5 offset:0
ds_read_b128 a[156:159], v5 offset:256
s_waitcnt lgkmcnt(0)
s_mov_b32 s59, 80
s_min_u32 s57, s59, s56
s_branch L_PGEN
L_SP80:
s_cmp_ge_u32 s35, 28
s_cbranch_scc0 L_on_38
s_waitcnt vmcnt(6)
v_lshrrev_b32 v5, 8, v0
v_lshlrev_b32 v5, 8, v5
v_bfe_u32 v96, v0, 4, 4
v_lshl_add_u32 v5, v96, 3, v5
s_lshl_b32 s77, s52, 12
s_add_u32 s77, s77, 131072
v_add_u32 v5, s77, v5
ds_read_b64_tr_b16 v[96:97], v5 offset:0
ds_read_b64_tr_b16 v[98:99], v5 offset:128
ds_read_b64_tr_b16 v[100:101], v5 offset:1024
ds_read_b64_tr_b16 v[102:103], v5 offset:1152
ds_read_b64_tr_b16 v[104:105], v5 offset:2048
ds_read_b64_tr_b16 v[106:107], v5 offset:2176
ds_read_b64_tr_b16 v[108:109], v5 offset:3072
ds_read_b64_tr_b16 v[110:111], v5 offset:3200
s_waitcnt lgkmcnt(0)
L_on_38:
s_mov_b32 s59, 86
s_min_u32 s57, s59, s56
s_branch L_PGEN
L_SP86:
s_waitcnt vmcnt(6)
v_xor_b32 v5, 0, v4
ds_read_b128 a[160:163], v5 offset:32768
ds_read_b128 a[176:179], v5 offset:33024
v_xor_b32 v5, 64, v4
ds_read_b128 a[164:167], v5 offset:32768
ds_read_b128 a[180:183], v5 offset:33024
v_xor_b32 v5, 128, v4
ds_read_b128 a[168:171], v5 offset:32768
ds_read_b128 a[184:187], v5 offset:33024
v_xor_b32 v5, 192, v4
ds_read_b128 a[172:175], v5 offset:32768
ds_read_b128 a[188:191], v5 offset:33024
s_waitcnt lgkmcnt(0)
s_mov_b32 s59, 94
s_min_u32 s57, s59, s56
s_branch L_PGEN
L_SP94:
s_waitcnt vmcnt(6)
v_xor_b32 v5, 65536, v4
ds_read_b128 a[192:195], v5 offset:0
ds_read_b128 a[208:211], v5 offset:256
v_xor_b32 v5, 65600, v4
ds_read_b128 a[196:199], v5 offset:0
ds_read_b128 a[212:215], v5 offset:256
v_xor_b32 v5, 65664, v4
ds_read_b128 a[200:203], v5 offset:0
ds_read_b128 a[216:219], v5 offset:256
v_xor_b32 v5, 65728, v4
ds_read_b128 a[204:207], v5 offset:0
ds_read_b128 a[220:223], v5 offset:256
s_waitcnt lgkmcnt(0)
s_mov_b32 s59, 96
s_min_u32 s57, s59, s56
s_branch L_PGEN
L_SP96:
s_add_u32 s36, s22, s53
s_addc_u32 s37, s23, 0
s_mov_b32 s38, 0x20000
s_lshl_b32 s54, s52, 10
v_lshrrev_b32 v5, 5, v0
v_and_b32 v5, 16, v5
v_xor_b32 v3, v5, v0
s_mov_b32 s59, 102
s_min_u32 s57, s59, s56
s_branch L_PGEN
L_CODE_END:
.section .rodata,"a"
.p2align 6
.amdhsa_kernel interleave_layers__sliding_block_cached__sliding_block_cached__decode_kernel
  .amdhsa_next_free_vgpr 512
  .amdhsa_next_free_sgpr 102
  .amdhsa_accum_offset 256
  .amdhsa_group_segment_fixed_size 0
  .amdhsa_kernarg_size 104
  .amdhsa_user_sgpr_count 2
  .amdhsa_user_sgpr_kernarg_segment_ptr 1
  .amdhsa_system_sgpr_workgroup_id_x 1
  .amdhsa_float_denorm_mode_32 3
.end_amdhsa_kernel
```
